```python
import torch

def _softmax(x, axis=-1):
    return torch.softmax(x, dim=axis)
def _gelu(x):
    return torch.nn.functional.gelu(x, approximate="tanh")
def _silu(x):
    return torch.nn.functional.silu(x)
def _sigmoid(x):
    return torch.sigmoid(x)
def _layernorm(x, axis=-1, eps=1e-5):
    m = x.mean(dim=axis, keepdim=True)
    v = x.var(dim=axis, keepdim=True, unbiased=False)
    return (x - m) / torch.sqrt(v + eps)
def _scatter_add(tgt, idx, src, axis=0):
    return tgt.clone().index_add_(axis, idx, src)
def _segment_sum(src, seg, n):
    out = torch.zeros((n,) + src.shape[1:], dtype=src.dtype)
    return out.index_add_(0, seg, src)
def _pad(x, pw):
    flat = tuple(v for pair in reversed(pw) for v in pair)
    return torch.nn.functional.pad(x, flat)

kernel_name = 'recurrent_scan__sliding_block_cached__swiglu_ffn__decode'

def setup_inputs():

    _w = (lambda a: (lambda t: t.to(torch.bfloat16) if t.is_floating_point() else t)(torch.as_tensor(a)))
    def _A_setup():
        B, Sq, D = 2, 1, 512
        Hq, Hkv, Sk, Dh = 32, 32, 8192, 128
        assert Hq % Hkv == 0, (Hq, Hkv)
        return {
            "x": _w((lambda *s: torch.randn(*s, dtype=torch.bfloat16) * 0.05)(B, Sq, D)),
            "k_cache": _w((lambda *s: torch.randn(*s, dtype=torch.bfloat16) * 1.6)(B, Hkv, Sk, Dh)),
            "v_cache": _w((lambda *s: torch.randn(*s, dtype=torch.bfloat16) * 0.2)(B, Hkv, Sk, Dh)),
            "wq": _w((lambda *s: torch.randn(*s, dtype=torch.bfloat16) * 1.6)(D, Hq * Dh) * (D ** -0.5)),
            "wo": _w((lambda *s: torch.randn(*s, dtype=torch.bfloat16) * 0.2)(Hq * Dh, D) * ((Hq * Dh) ** -0.5)),
        }
    _A_in = _A_setup()

    def _B_setup():
        B, S, D, F = 2, 1, 512, 1376
        return {
            "x": _w((lambda *s: torch.randn(*s, dtype=torch.bfloat16) * 0.05)(B, S, D)),
            "w_gate": _w((lambda *s: torch.randn(*s, dtype=torch.bfloat16) * 0.1)(D, F)),
            "w_up": _w((lambda *s: torch.randn(*s, dtype=torch.bfloat16) * 0.1)(D, F)),
            "w_down": _w((lambda *s: torch.randn(*s, dtype=torch.bfloat16) * 0.1)(F, D)),
        }
    _B_in = _B_setup()

    return {
        "A_x": _A_in["x"],
        "A_k_cache": _A_in["k_cache"],
        "A_v_cache": _A_in["v_cache"],
        "A_wq": _A_in["wq"],
        "A_wo": _A_in["wo"],
        "B_x": _B_in["x"],
        "B_w_gate": _B_in["w_gate"],
        "B_w_up": _B_in["w_up"],
        "B_w_down": _B_in["w_down"],
    }

def reference(A_x, A_k_cache, A_v_cache, A_wq, A_wo, B_x, B_w_gate, B_w_up, B_w_down):
    def _A_ref(x, k_cache, v_cache, wq, wo):
        B, Sq, D = x.shape
        Hq, Dh = 32, 128
        Hkv, Sk = k_cache.shape[1], k_cache.shape[2]
        W = min(4096, max(256, Sk // 4))
        rep = Hq // Hkv
        q = (lambda x, *d: x.permute(*d))((x @ wq).reshape(B, Sq, Hq, Dh), 0, 2, 1, 3)
        k = (lambda x, n, axis: torch.repeat_interleave(x, n, dim=axis))(k_cache[:, :, Sk - W:, :], rep, axis=1)
        v = (lambda x, n, axis: torch.repeat_interleave(x, n, dim=axis))(v_cache[:, :, Sk - W:, :], rep, axis=1)
        scores = torch.einsum("bhqd,bhkd->bhqk", q, k) * (Dh ** -0.5)
        p = _softmax(scores, axis=-1)
        o = torch.einsum("bhqk,bhkd->bhqd", p, v)
        return (lambda x, *d: x.permute(*d))(o, 0, 2, 1, 3).reshape(B, Sq, Hq * Dh) @ wo

    def _B_ref(x, w_gate, w_up, w_down):
        g = _silu(x @ w_gate)
        u = x @ w_up
        return (g * u) @ w_down

    x = A_x
    xn = _layernorm(x, axis=-1)
    s = _A_ref(xn, A_k_cache, A_v_cache, A_wq, A_wo)
    g = _silu(_B_ref(xn, B_w_gate, B_w_up, B_w_down))
    return x + s * g
```

```asm
; @launch grid=(256,1,1) block=(640,1,1) lds=6144
.amdgcn_target "amdgcn-amd-amdhsa--gfx950"
.text
.globl recurrent_scan__sliding_block_cached__swiglu_ffn__decode_kernel
.p2align 8
.type recurrent_scan__sliding_block_cached__swiglu_ffn__decode_kernel,@function
recurrent_scan__sliding_block_cached__swiglu_ffn__decode_kernel:
    s_cmp_gt_u32 s2, 255
    s_cbranch_scc1 L_END
    s_load_dwordx16 s[16:31], s[0:1], 0
    s_load_dwordx8 s[32:39], s[0:1], 64
    s_getpc_b64 s[40:41]
    s_and_b32 s40, s40, 0xffffff00
    s_mov_b32 s42, L_END+4-recurrent_scan__sliding_block_cached__swiglu_ffn__decode_kernel
    s_mov_b32 s43, 0x20000
    v_lshlrev_b32 v1, 6, v0
    v_add_u32 v1, 4294959104, v1
    buffer_load_dword v167, v1, s[40:43], 0 offen
    v_lshrrev_b32 v2, 6, v0
    v_and_b32 v1, 63, v0
    v_mov_b32 v3, 0
    v_readfirstlane_b32 s3, v2
    v_lshlrev_b32 v2, 2, v1
    ds_write_b32 v2, v3
    s_lshr_b32 s5, s2, 7
    s_and_b32 s4, s2, 31
    s_lshr_b32 s8, s2, 5
    s_and_b32 s6, s8, 3
    s_lshl_b32 s7, s4, 3
    s_add_u32 s7, s7, s8
    s_mov_b32 s9, 1048576
    v_lshlrev_b32 v2, 4, v1
    s_cmp_lt_u32 s3, 2
    s_cbranch_scc1 L_AUX
    s_lshl_b32 s10, s5, 26
    s_lshl_b32 s11, s4, 21
    s_add_u32 s10, s10, s11
    s_lshl_b32 s11, s6, 17
    s_add_u32 s10, s10, s11
    s_lshl_b32 s11, s3, 14
    s_add_u32 s10, s10, s11
    s_add_u32 s10, s10, 1540096
    s_mul_i32 s12, s3, 2048
    s_and_b32 s13, s2, 7
    s_mul_i32 s13, s13, 1024
    s_add_u32 s12, s12, s13
    s_bfe_u32 s13, s2, 0x20003
    s_mul_i32 s13, s13, 4096
    s_add_u32 s12, s12, s13
    s_mov_b32 s13, s6
    s_mul_i32 s13, s13, 8192
    s_add_u32 s12, s12, s13
    s_mov_b32 s42, 16384
    s_mov_b32 s43, 0x20000
    s_mov_b32 s46, 16384
    s_mov_b32 s47, 0x20000
    s_add_u32 s64, s12, 0
    s_and_b32 s64, s64, 0x3c00
    s_add_u32 s65, s12, 1024
    s_and_b32 s65, s65, 0x3c00
    s_add_u32 s66, s12, 2048
    s_and_b32 s66, s66, 0x3c00
    s_waitcnt lgkmcnt(0)
    s_add_u32 s40, s18, s10
    s_addc_u32 s41, s19, 0
    s_add_u32 s44, s20, s10
    s_addc_u32 s45, s21, 0
    buffer_load_dwordx4 v[72:75], v2, s[44:47], s64 offen nt
    s_barrier
    buffer_load_dwordx4 v[76:79], v2, s[44:47], s65 offen nt
    buffer_load_dwordx4 v[80:83], v2, s[44:47], s66 offen nt
    s_add_u32 s67, s12, 3072
    s_and_b32 s67, s67, 0x3c00
    s_add_u32 s68, s12, 4096
    s_and_b32 s68, s68, 0x3c00
    s_add_u32 s69, s12, 5120
    s_and_b32 s69, s69, 0x3c00
    s_add_u32 s70, s12, 6144
    s_and_b32 s70, s70, 0x3c00
    s_add_u32 s71, s12, 7168
    s_and_b32 s71, s71, 0x3c00
    s_add_u32 s72, s12, 8192
    s_and_b32 s72, s72, 0x3c00
    s_add_u32 s73, s12, 9216
    s_and_b32 s73, s73, 0x3c00
    s_add_u32 s74, s12, 10240
    s_and_b32 s74, s74, 0x3c00
    s_add_u32 s75, s12, 11264
    s_and_b32 s75, s75, 0x3c00
    s_add_u32 s76, s12, 12288
    s_and_b32 s76, s76, 0x3c00
    s_add_u32 s77, s12, 13312
    s_and_b32 s77, s77, 0x3c00
    s_add_u32 s78, s12, 14336
    s_and_b32 s78, s78, 0x3c00
    s_add_u32 s79, s12, 15360
    s_and_b32 s79, s79, 0x3c00
    v_and_b32 v3, 15, v1
    v_bfe_u32 v157, v1, 1, 2
    v_lshlrev_b32 v158, 4, v1
    v_and_b32 v158, 16, v158
    v_mov_b32 v159, 0x0c0c0100
    v_mov_b32 v160, 0x0c0c0302
    v_cmp_lt_u32 vcc, 7, v3
    v_mov_b32 v161, 0x0c0c0c0c
    v_lshlrev_b32 v3, 4, v3
    v_cndmask_b32 v159, v159, v160, vcc
    v_mov_b32 v162, 0
    v_alignbit_b32 v159, v159, v159, v158
    v_cmp_eq_u32 vcc, 0, v157
    v_mov_b32 v136, 0
    v_mov_b32 v137, 0
    v_cndmask_b32 v152, v161, v159, vcc
    v_mov_b32 v138, 0
    v_mov_b32 v139, 0
    v_cmp_eq_u32 vcc, 1, v157
    v_mov_b32 v140, 0
    v_mov_b32 v141, 0
    v_cndmask_b32 v153, v161, v159, vcc
    v_mov_b32 v142, 0
    v_mov_b32 v143, 0
    v_cmp_eq_u32 vcc, 2, v157
    v_mov_b32 v144, 0
    v_mov_b32 v145, 0
    v_cndmask_b32 v154, v161, v159, vcc
    v_mov_b32 v146, 0
    v_mov_b32 v147, 0
    v_cmp_eq_u32 vcc, 3, v157
    v_mov_b32 v148, 0
    v_mov_b32 v149, 0
    v_cndmask_b32 v155, v161, v159, vcc
    v_mov_b32 v150, 0
    v_mov_b32 v151, 0
    s_mov_b32 s56, s38
    s_mov_b32 s57, s39
    s_mov_b32 s58, 0x20000000
    s_mov_b32 s59, 0x20000
    s_mov_b32 s96, 0xcccccccc
    s_mov_b32 s97, 0xcccccccc
    s_mov_b32 s98, 0xaaaaaaaa
    s_mov_b32 s99, 0xaaaaaaaa
    v_and_b32 v163, 15, v1
    v_lshlrev_b32 v163, 5, v163
    v_and_b32 v164, 16, v1
    v_add_u32 v163, v163, v164
    v_lshrrev_b32 v164, 5, v1
    v_lshl_add_u32 v163, v164, 3, v163
    s_lshl_b32 s15, s3, 9
    v_add_u32 v161, s15, v163
    s_lshl_b32 s101, s7, 10
    s_add_u32 s101, s101, 1572864
    v_add_u32 v166, 262144, v2
    v_mov_b32 v165, 1
    v_mov_b32 v0, 0xfffffc00
    v_and_b32 v164, 7, v1
    v_lshlrev_b32 v164, 3, v164
    s_waitcnt vmcnt(2)
    buffer_load_dwordx4 v[84:87], v2, s[44:47], s67 offen nt
    s_waitcnt vmcnt(2)
    buffer_load_dwordx4 v[88:91], v2, s[44:47], s68 offen nt
    s_waitcnt vmcnt(2)
    buffer_load_dwordx4 v[92:95], v2, s[44:47], s69 offen nt
    s_waitcnt vmcnt(2)
    buffer_load_dwordx4 v[96:99], v2, s[44:47], s70 offen nt
    s_waitcnt vmcnt(2)
    buffer_load_dwordx4 v[100:103], v2, s[44:47], s71 offen nt
    s_waitcnt vmcnt(2)
    buffer_load_dwordx4 v[8:11], v2, s[40:43], s64 offen nt
    s_waitcnt vmcnt(2)
    buffer_load_dwordx4 v[12:15], v2, s[40:43], s65 offen nt
    s_waitcnt vmcnt(2)
    buffer_load_dwordx4 v[16:19], v2, s[40:43], s66 offen nt
    s_waitcnt vmcnt(2)
    buffer_load_dwordx4 v[20:23], v2, s[40:43], s67 offen nt
    s_waitcnt vmcnt(2)
    buffer_load_dwordx4 v[24:27], v2, s[40:43], s68 offen nt
    s_waitcnt vmcnt(2)
    buffer_load_dwordx4 v[28:31], v2, s[40:43], s69 offen nt
    s_waitcnt vmcnt(2)
    buffer_load_dwordx4 v[32:35], v2, s[40:43], s70 offen nt
    s_waitcnt vmcnt(2)
    buffer_load_dwordx4 v[36:39], v2, s[40:43], s71 offen nt
    buffer_load_dwordx4 v[40:43], v2, s[40:43], s72 offen nt
    buffer_load_dwordx4 v[44:47], v2, s[40:43], s73 offen nt
    buffer_load_dwordx4 v[48:51], v2, s[40:43], s74 offen nt
    buffer_load_dwordx4 v[52:55], v2, s[40:43], s75 offen nt
    buffer_load_dwordx4 v[56:59], v2, s[40:43], s76 offen nt
    buffer_load_dwordx4 v[60:63], v2, s[40:43], s77 offen nt
    buffer_load_dwordx4 v[64:67], v2, s[40:43], s78 offen nt
    s_waitcnt vmcnt(9)
    buffer_load_dwordx4 v[68:71], v2, s[40:43], s79 offen nt
    s_waitcnt vmcnt(9)
    buffer_load_dwordx4 v[104:107], v2, s[44:47], s72 offen nt
    s_waitcnt vmcnt(9)
    buffer_load_dwordx4 v[108:111], v2, s[44:47], s73 offen nt
L_SQ:
    ds_read_b32 v157, v162 offset:4
    ds_read_b128 v[4:7], v3 offset:256
    s_sub_u32 s9, s9, 1
    s_cbranch_scc1 L_END
    s_waitcnt lgkmcnt(0)
    v_readfirstlane_b32 s15, v157
    s_cmp_eq_u32 s15, 0
    s_cbranch_scc1 L_SQ
    s_bfe_u32 s52, s15, 524288
    s_or_b32 s52, s52, 0x300
    s_bfe_u32 s53, s15, 524296
    s_or_b32 s53, s53, 0x300
    s_bfe_u32 s54, s15, 524304
    s_or_b32 s54, s54, 0x300
    s_bfe_u32 s55, s15, 524312
    s_or_b32 s55, s55, 0x300
    v_dot2c_f32_bf16 v136, v8, v4
    v_dot2c_f32_bf16 v136, v9, v5
    v_dot2c_f32_bf16 v136, v10, v6
    v_dot2c_f32_bf16 v136, v11, v7
    v_dot2c_f32_bf16 v137, v12, v4
    v_dot2c_f32_bf16 v137, v13, v5
    v_dot2c_f32_bf16 v137, v14, v6
    v_dot2c_f32_bf16 v137, v15, v7
    v_dot2c_f32_bf16 v138, v16, v4
    v_dot2c_f32_bf16 v138, v17, v5
    v_dot2c_f32_bf16 v138, v18, v6
    v_dot2c_f32_bf16 v138, v19, v7
    v_dot2c_f32_bf16 v139, v20, v4
    v_dot2c_f32_bf16 v139, v21, v5
    v_dot2c_f32_bf16 v139, v22, v6
    v_dot2c_f32_bf16 v139, v23, v7
    v_dot2c_f32_bf16 v140, v24, v4
    v_dot2c_f32_bf16 v140, v25, v5
    v_dot2c_f32_bf16 v140, v26, v6
    v_dot2c_f32_bf16 v140, v27, v7
    v_dot2c_f32_bf16 v141, v28, v4
    v_dot2c_f32_bf16 v141, v29, v5
    v_dot2c_f32_bf16 v141, v30, v6
    v_dot2c_f32_bf16 v141, v31, v7
    v_dot2c_f32_bf16 v142, v32, v4
    v_dot2c_f32_bf16 v142, v33, v5
    v_dot2c_f32_bf16 v142, v34, v6
    v_dot2c_f32_bf16 v142, v35, v7
    v_dot2c_f32_bf16 v143, v36, v4
    v_dot2c_f32_bf16 v143, v37, v5
    v_dot2c_f32_bf16 v143, v38, v6
    v_dot2c_f32_bf16 v143, v39, v7
    s_waitcnt vmcnt(9)
    buffer_load_dwordx4 v[112:115], v2, s[44:47], s74 offen nt
    v_dot2c_f32_bf16 v144, v40, v4
    v_dot2c_f32_bf16 v144, v41, v5
    v_dot2c_f32_bf16 v144, v42, v6
    v_dot2c_f32_bf16 v144, v43, v7
    s_waitcnt vmcnt(9)
    buffer_load_dwordx4 v[116:119], v2, s[44:47], s75 offen nt
    v_dot2c_f32_bf16 v145, v44, v4
    v_dot2c_f32_bf16 v145, v45, v5
    v_dot2c_f32_bf16 v145, v46, v6
    v_dot2c_f32_bf16 v145, v47, v7
    s_waitcnt vmcnt(9)
    buffer_load_dwordx4 v[120:123], v2, s[44:47], s76 offen nt
    ds_write_b32 v162, v165 offset:28
    v_dot2c_f32_bf16 v146, v48, v4
    v_dot2c_f32_bf16 v146, v49, v5
    v_dot2c_f32_bf16 v146, v50, v6
    v_dot2c_f32_bf16 v146, v51, v7
    s_waitcnt vmcnt(9)
    buffer_load_dwordx4 v[124:127], v2, s[44:47], s77 offen nt
    v_dot2c_f32_bf16 v147, v52, v4
    v_dot2c_f32_bf16 v147, v53, v5
    v_dot2c_f32_bf16 v147, v54, v6
    v_dot2c_f32_bf16 v147, v55, v7
    s_waitcnt vmcnt(9)
    buffer_load_dwordx4 v[128:131], v2, s[44:47], s78 offen nt
    v_dot2c_f32_bf16 v148, v56, v4
    v_dot2c_f32_bf16 v148, v57, v5
    v_dot2c_f32_bf16 v148, v58, v6
    v_dot2c_f32_bf16 v148, v59, v7
    s_waitcnt vmcnt(9)
    buffer_load_dwordx4 v[132:135], v2, s[44:47], s79 offen nt
    v_dot2c_f32_bf16 v149, v60, v4
    v_dot2c_f32_bf16 v149, v61, v5
    v_dot2c_f32_bf16 v149, v62, v6
    v_dot2c_f32_bf16 v149, v63, v7
    s_waitcnt vmcnt(9)
    v_dot2c_f32_bf16 v150, v64, v4
    v_dot2c_f32_bf16 v150, v65, v5
    v_dot2c_f32_bf16 v150, v66, v6
    v_dot2c_f32_bf16 v150, v67, v7
    s_waitcnt vmcnt(8)
    v_dot2c_f32_bf16 v151, v68, v4
    v_dot2c_f32_bf16 v151, v69, v5
    v_dot2c_f32_bf16 v151, v70, v6
    v_dot2c_f32_bf16 v151, v71, v7
    v_add_f32_dpp v136, v136, v136 row_ror:8 row_mask:0xf bank_mask:0x3
    v_add_f32_dpp v137, v137, v137 row_ror:8 row_mask:0xf bank_mask:0x3
    v_add_f32_dpp v138, v138, v138 row_ror:8 row_mask:0xf bank_mask:0x3
    v_add_f32_dpp v139, v139, v139 row_ror:8 row_mask:0xf bank_mask:0x3
    v_add_f32_dpp v140, v140, v140 row_ror:8 row_mask:0xf bank_mask:0x3
    v_add_f32_dpp v141, v141, v141 row_ror:8 row_mask:0xf bank_mask:0x3
    v_add_f32_dpp v142, v142, v142 row_ror:8 row_mask:0xf bank_mask:0x3
    v_add_f32_dpp v143, v143, v143 row_ror:8 row_mask:0xf bank_mask:0x3
    v_add_f32_dpp v136, v144, v144 row_ror:8 row_mask:0xf bank_mask:0xc
    v_add_f32_dpp v137, v145, v145 row_ror:8 row_mask:0xf bank_mask:0xc
    v_add_f32_dpp v138, v146, v146 row_ror:8 row_mask:0xf bank_mask:0xc
    v_add_f32_dpp v139, v147, v147 row_ror:8 row_mask:0xf bank_mask:0xc
    v_add_f32_dpp v140, v148, v148 row_ror:8 row_mask:0xf bank_mask:0xc
    v_add_f32_dpp v141, v149, v149 row_ror:8 row_mask:0xf bank_mask:0xc
    v_add_f32_dpp v142, v150, v150 row_ror:8 row_mask:0xf bank_mask:0xc
    v_add_f32_dpp v143, v151, v151 row_ror:8 row_mask:0xf bank_mask:0xc
    v_add_f32_dpp v136, v136, v136 row_half_mirror row_mask:0xf bank_mask:0x5
    v_add_f32_dpp v137, v137, v137 row_half_mirror row_mask:0xf bank_mask:0x5
    v_add_f32_dpp v138, v138, v138 row_half_mirror row_mask:0xf bank_mask:0x5
    v_add_f32_dpp v139, v139, v139 row_half_mirror row_mask:0xf bank_mask:0x5
    v_add_f32_dpp v136, v140, v140 row_half_mirror row_mask:0xf bank_mask:0xa
    v_add_f32_dpp v137, v141, v141 row_half_mirror row_mask:0xf bank_mask:0xa
    v_add_f32_dpp v138, v142, v142 row_half_mirror row_mask:0xf bank_mask:0xa
    v_add_f32_dpp v139, v143, v143 row_half_mirror row_mask:0xf bank_mask:0xa
    v_add_f32_dpp v136, v136, v136 quad_perm:[2,3,0,1] row_mask:0xf bank_mask:0xf
    v_add_f32_dpp v137, v137, v137 quad_perm:[2,3,0,1] row_mask:0xf bank_mask:0xf
    v_add_f32_dpp v138, v138, v138 quad_perm:[2,3,0,1] row_mask:0xf bank_mask:0xf
    v_add_f32_dpp v139, v139, v139 quad_perm:[2,3,0,1] row_mask:0xf bank_mask:0xf
    v_cndmask_b32 v136, v136, v138, s[96:97]
    v_cndmask_b32 v137, v137, v139, s[96:97]
    s_nop 0
    v_add_f32_dpp v136, v136, v136 quad_perm:[1,0,3,2] row_mask:0xf bank_mask:0xf
    v_add_f32_dpp v137, v137, v137 quad_perm:[1,0,3,2] row_mask:0xf bank_mask:0xf
    v_cndmask_b32 v136, v136, v137, s[98:99]
    v_cvt_pk_bf16_f32 v136, v136, v136
    v_lshlrev_b32 v136, 16, v136
    v_mul_f32 v136, 0x3db504f3, v136
    v_cvt_pk_bf16_f32 v136, v136, v136
    v_lshlrev_b32 v136, 16, v136
    s_nop 1
    v_max_f32_dpp v137, v136, v136 row_ror:8 row_mask:0xf bank_mask:0xf
    s_nop 1
    v_max_f32_dpp v137, v137, v137 row_ror:4 row_mask:0xf bank_mask:0xf
    s_nop 1
    v_max_f32_dpp v137, v137, v137 row_ror:2 row_mask:0xf bank_mask:0xf
    s_nop 1
    v_max_f32_dpp v137, v137, v137 row_ror:1 row_mask:0xf bank_mask:0xf
    s_nop 1
    v_max_f32_dpp v137, v137, v137 row_bcast:15 row_mask:0xa bank_mask:0xf
    s_nop 1
    v_max_f32_dpp v137, v137, v137 row_bcast:31 row_mask:0xc bank_mask:0xf
    s_nop 0
    v_readlane_b32 s100, v137, 63
    s_nop 1
    v_subrev_f32 v136, s100, v136
    v_mul_f32 v136, 0x3fb8aa3b, v136
    v_exp_f32 v136, v136
    v_mov_b32 v138, s100
    s_nop 0
    v_add_f32_dpp v139, v136, v136 row_ror:8 row_mask:0xf bank_mask:0xf
    v_cvt_pk_bf16_f32 v140, v136, v136
    v_lshlrev_b32 v140, 16, v140
    v_add_f32_dpp v139, v139, v139 row_ror:4 row_mask:0xf bank_mask:0xf
    v_sub_f32 v140, v136, v140
    v_cvt_pk_bf16_f32 v156, v136, v140
    v_add_f32_dpp v139, v139, v139 row_ror:2 row_mask:0xf bank_mask:0xf
    v_mov_b32 v20, 0
    v_mov_b32 v21, 0
    v_add_f32_dpp v139, v139, v139 row_ror:1 row_mask:0xf bank_mask:0xf
    v_mov_b32 v22, 0
    v_mov_b32 v23, 0
    v_add_f32_dpp v139, v139, v139 row_bcast:15 row_mask:0xa bank_mask:0xf
    s_lshl_b32 s15, s3, 3
    v_mov_b32 v141, s15
    v_add_f32_dpp v139, v139, v139 row_bcast:31 row_mask:0xc bank_mask:0xf
    v_mov_b32 v142, 1
    s_lshl_b64 exec, 1, 63
    ds_write_b64 v141, v[138:139] offset:48
    ds_add_u32 v162, v142 offset:8
    s_mov_b64 exec, -1
    v_mov_b32_dpp v16, v156 row_newbcast:0 row_mask:0xf bank_mask:0xf
    v_perm_b32 v8, v16, v16, v152
    v_perm_b32 v9, v16, v16, v153
    v_perm_b32 v10, v16, v16, v154
    v_perm_b32 v11, v16, v16, v155
    s_nop 1
    v_mfma_f32_16x16x32_bf16 v[20:23], v[8:11], v[72:75], v[20:23]
    v_mov_b32_dpp v17, v156 row_newbcast:1 row_mask:0xf bank_mask:0xf
    v_perm_b32 v12, v17, v17, v152
    v_perm_b32 v13, v17, v17, v153
    v_perm_b32 v14, v17, v17, v154
    v_perm_b32 v15, v17, v17, v155
    s_nop 1
    v_mfma_f32_16x16x32_bf16 v[20:23], v[12:15], v[76:79], v[20:23]
    v_mov_b32_dpp v16, v156 row_newbcast:2 row_mask:0xf bank_mask:0xf
    v_perm_b32 v8, v16, v16, v152
    v_perm_b32 v9, v16, v16, v153
    v_perm_b32 v10, v16, v16, v154
    v_perm_b32 v11, v16, v16, v155
    s_nop 1
    v_mfma_f32_16x16x32_bf16 v[20:23], v[8:11], v[80:83], v[20:23]
    v_mov_b32_dpp v17, v156 row_newbcast:3 row_mask:0xf bank_mask:0xf
    v_perm_b32 v12, v17, v17, v152
    v_perm_b32 v13, v17, v17, v153
    v_perm_b32 v14, v17, v17, v154
    v_perm_b32 v15, v17, v17, v155
    s_nop 1
    v_mfma_f32_16x16x32_bf16 v[20:23], v[12:15], v[84:87], v[20:23]
    v_mov_b32_dpp v16, v156 row_newbcast:4 row_mask:0xf bank_mask:0xf
    v_perm_b32 v8, v16, v16, v152
    v_perm_b32 v9, v16, v16, v153
    v_perm_b32 v10, v16, v16, v154
    v_perm_b32 v11, v16, v16, v155
    s_nop 1
    v_mfma_f32_16x16x32_bf16 v[20:23], v[8:11], v[88:91], v[20:23]
    v_mov_b32_dpp v17, v156 row_newbcast:5 row_mask:0xf bank_mask:0xf
    v_perm_b32 v12, v17, v17, v152
    v_perm_b32 v13, v17, v17, v153
    v_perm_b32 v14, v17, v17, v154
    v_perm_b32 v15, v17, v17, v155
    s_nop 1
    v_mfma_f32_16x16x32_bf16 v[20:23], v[12:15], v[92:95], v[20:23]
    v_mov_b32_dpp v16, v156 row_newbcast:6 row_mask:0xf bank_mask:0xf
    v_perm_b32 v8, v16, v16, v152
    v_perm_b32 v9, v16, v16, v153
    v_perm_b32 v10, v16, v16, v154
    v_perm_b32 v11, v16, v16, v155
    s_nop 1
    v_mfma_f32_16x16x32_bf16 v[20:23], v[8:11], v[96:99], v[20:23]
    v_mov_b32_dpp v17, v156 row_newbcast:7 row_mask:0xf bank_mask:0xf
    v_perm_b32 v12, v17, v17, v152
    v_perm_b32 v13, v17, v17, v153
    v_perm_b32 v14, v17, v17, v154
    v_perm_b32 v15, v17, v17, v155
    s_nop 1
    v_mfma_f32_16x16x32_bf16 v[20:23], v[12:15], v[100:103], v[20:23]
L_SG:
    ds_read_b32 v157, v162 offset:8
    ds_read_b32 v158, v164 offset:64
    s_sub_u32 s9, s9, 1
    s_cbranch_scc1 L_END
    s_waitcnt lgkmcnt(0)
    v_readfirstlane_b32 s15, v157
    s_cmp_lg_u32 s15, 8
    s_cbranch_scc1 L_SG
    v_max_f32_dpp v158, v158, v158 quad_perm:[1,0,3,2] row_mask:0xf bank_mask:0xf
    s_nop 1
    v_max_f32_dpp v158, v158, v158 quad_perm:[2,3,0,1] row_mask:0xf bank_mask:0xf
    s_nop 1
    v_max_f32_dpp v158, v158, v158 row_half_mirror row_mask:0xf bank_mask:0xf
    v_sub_f32 v158, s100, v158
    v_mul_f32 v158, 0x3fb8aa3b, v158
    v_exp_f32 v158, v158
    v_mov_b32_dpp v16, v156 row_newbcast:8 row_mask:0xf bank_mask:0xf
    v_perm_b32 v8, v16, v16, v152
    v_perm_b32 v9, v16, v16, v153
    v_perm_b32 v10, v16, v16, v154
    v_perm_b32 v11, v16, v16, v155
    s_waitcnt vmcnt(7)
    s_nop 0
    v_mfma_f32_16x16x32_bf16 v[20:23], v[8:11], v[104:107], v[20:23]
    v_mov_b32_dpp v17, v156 row_newbcast:9 row_mask:0xf bank_mask:0xf
    v_perm_b32 v12, v17, v17, v152
    v_perm_b32 v13, v17, v17, v153
    v_perm_b32 v14, v17, v17, v154
    v_perm_b32 v15, v17, v17, v155
    s_waitcnt vmcnt(6)
    s_nop 0
    v_mfma_f32_16x16x32_bf16 v[20:23], v[12:15], v[108:111], v[20:23]
    v_mov_b32_dpp v16, v156 row_newbcast:10 row_mask:0xf bank_mask:0xf
    v_perm_b32 v8, v16, v16, v152
    v_perm_b32 v9, v16, v16, v153
    v_perm_b32 v10, v16, v16, v154
    v_perm_b32 v11, v16, v16, v155
    s_waitcnt vmcnt(5)
    s_nop 0
    v_mfma_f32_16x16x32_bf16 v[20:23], v[8:11], v[112:115], v[20:23]
    v_mov_b32_dpp v17, v156 row_newbcast:11 row_mask:0xf bank_mask:0xf
    v_perm_b32 v12, v17, v17, v152
    v_perm_b32 v13, v17, v17, v153
    v_perm_b32 v14, v17, v17, v154
    v_perm_b32 v15, v17, v17, v155
    s_waitcnt vmcnt(4)
    s_nop 0
    v_mfma_f32_16x16x32_bf16 v[20:23], v[12:15], v[116:119], v[20:23]
    v_mov_b32_dpp v16, v156 row_newbcast:12 row_mask:0xf bank_mask:0xf
    v_perm_b32 v8, v16, v16, v152
    v_perm_b32 v9, v16, v16, v153
    v_perm_b32 v10, v16, v16, v154
    v_perm_b32 v11, v16, v16, v155
    s_waitcnt vmcnt(3)
    s_nop 0
    v_mfma_f32_16x16x32_bf16 v[20:23], v[8:11], v[120:123], v[20:23]
    v_mov_b32_dpp v17, v156 row_newbcast:13 row_mask:0xf bank_mask:0xf
    v_perm_b32 v12, v17, v17, v152
    v_perm_b32 v13, v17, v17, v153
    v_perm_b32 v14, v17, v17, v154
    v_perm_b32 v15, v17, v17, v155
    s_waitcnt vmcnt(2)
    s_nop 0
    v_mfma_f32_16x16x32_bf16 v[20:23], v[12:15], v[124:127], v[20:23]
    v_mov_b32_dpp v16, v156 row_newbcast:14 row_mask:0xf bank_mask:0xf
    v_perm_b32 v8, v16, v16, v152
    v_perm_b32 v9, v16, v16, v153
    v_perm_b32 v10, v16, v16, v154
    v_perm_b32 v11, v16, v16, v155
    s_waitcnt vmcnt(1)
    s_nop 0
    v_mfma_f32_16x16x32_bf16 v[20:23], v[8:11], v[128:131], v[20:23]
    v_mov_b32_dpp v17, v156 row_newbcast:15 row_mask:0xf bank_mask:0xf
    v_perm_b32 v12, v17, v17, v152
    v_perm_b32 v13, v17, v17, v153
    v_perm_b32 v14, v17, v17, v154
    v_perm_b32 v15, v17, v17, v155
    s_waitcnt vmcnt(0)
    s_nop 0
    v_mfma_f32_16x16x32_bf16 v[20:23], v[12:15], v[132:135], v[20:23]
    s_nop 7
    v_permlane32_swap_b32 v20, v22
    v_permlane32_swap_b32 v21, v23
    v_pk_add_f32 v[20:21], v[20:21], v[22:23]
    v_pk_mul_f32 v[20:21], v[20:21], v[158:159] op_sel_hi:[1,0]
    ds_write_b64 v161, v[20:21] offset:0
    s_mov_b64 exec, 1
    ds_add_rtn_u32 v157, v162, v165 offset:12
    s_mov_b64 exec, 0xffffffff
    ds_read_b128 v[24:27], v2 offset:1024
    ds_read_b128 v[28:31], v2 offset:1536
    ds_read_b128 v[32:35], v2 offset:2048
    ds_read_b128 v[36:39], v2 offset:2560
    ds_read_b128 v[40:43], v2 offset:3072
    ds_read_b128 v[44:47], v2 offset:3584
    ds_read_b128 v[48:51], v2 offset:4096
    ds_read_b128 v[52:55], v2 offset:4608
    s_waitcnt lgkmcnt(8)
    v_readfirstlane_b32 s15, v157
    s_cmp_lg_u32 s15, 7
    s_cbranch_scc1 L_END
    s_waitcnt lgkmcnt(6)
    v_pk_add_f32 v[24:25], v[24:25], v[28:29]
    v_pk_add_f32 v[26:27], v[26:27], v[30:31]
    s_waitcnt lgkmcnt(4)
    v_pk_add_f32 v[32:33], v[32:33], v[36:37]
    v_pk_add_f32 v[34:35], v[34:35], v[38:39]
    v_pk_add_f32 v[24:25], v[24:25], v[32:33]
    v_pk_add_f32 v[26:27], v[26:27], v[34:35]
    s_waitcnt lgkmcnt(2)
    v_pk_add_f32 v[40:41], v[40:41], v[44:45]
    v_pk_add_f32 v[42:43], v[42:43], v[46:47]
    v_pk_add_f32 v[24:25], v[24:25], v[40:41]
    v_pk_add_f32 v[26:27], v[26:27], v[42:43]
    s_waitcnt lgkmcnt(0)
    v_pk_add_f32 v[48:49], v[48:49], v[52:53]
    v_pk_add_f32 v[50:51], v[50:51], v[54:55]
    v_pk_add_f32 v[24:25], v[24:25], v[48:49]
    v_pk_add_f32 v[26:27], v[26:27], v[50:51]
    v_and_or_b32 v24, v24, v0, s52
    v_and_or_b32 v25, v25, v0, s53
    v_and_or_b32 v26, v26, v0, s54
    v_and_or_b32 v27, v27, v0, s55
    buffer_store_dwordx4 v[24:27], v166, s[56:59], s101 offen
    s_mov_b64 exec, 1
    ds_add_u32 v162, v165 offset:12
    s_mov_b64 exec, 0xffffffff
    buffer_store_dwordx4 v[24:27], v2, s[56:59], s101 offen sc1
    s_endpgm
L_AUX:
    s_setprio 3
    s_memrealtime s[14:15]
    v_and_b32 v3, 15, v1
    v_lshrrev_b32 v4, 4, v1
    v_lshlrev_b32 v2, 4, v3
    v_and_b32 v5, 7, v1
    v_lshl_add_u32 v5, v4, 3, v5
    v_lshlrev_b32 v5, 5, v5
    v_and_b32 v6, 8, v1
    v_lshlrev_b32 v6, 7, v6
    v_add_u32 v5, v5, v6
    s_mov_b32 s42, 2048
    s_mov_b32 s43, 0x20000
    s_mov_b32 s58, 0x20000000
    s_mov_b32 s59, 0x20000
    s_mov_b32 s62, 256
    s_mov_b32 s63, 0x20000
    s_cmp_eq_u32 s3, 1
    s_cbranch_scc1 L_W1
    v_lshl_add_u32 v6, v4, 5, v6
    v_lshl_add_u32 v7, v4, 17, v2
    s_lshl_b32 s10, s8, 7
    s_lshl_b32 s11, s8, 19
    s_lshl_b32 s12, s4, 8
    s_add_u32 s11, s11, s12
    s_mov_b32 s46, 0x400000
    s_mov_b32 s47, 0x20000
    s_waitcnt lgkmcnt(0)
    s_mov_b32 s40, s16
    s_mov_b32 s41, s17
    s_mov_b32 s44, s22
    s_mov_b32 s45, s23
    buffer_load_dwordx4 v[8:11], v5, s[40:43], 0 offen
    buffer_load_dwordx4 v[12:15], v5, s[40:43], 0 offen offset:16
    buffer_load_dwordx4 v[16:19], v6, s[40:43], s10 offen
    buffer_load_dwordx4 v[20:23], v6, s[40:43], s10 offen offset:16
    buffer_load_dwordx4 v[96:99], v7, s[44:47], s11 offen nt
    s_add_u32 s11, s11, 0x2000
    buffer_load_dwordx4 v[100:103], v7, s[44:47], s11 offen nt
    s_add_u32 s11, s11, 0x2000
    buffer_load_dwordx4 v[104:107], v7, s[44:47], s11 offen nt
    s_add_u32 s11, s11, 0x2000
    buffer_load_dwordx4 v[108:111], v7, s[44:47], s11 offen nt
    s_add_u32 s11, s11, 0x2000
    buffer_load_dwordx4 v[112:115], v7, s[44:47], s11 offen nt
    s_add_u32 s11, s11, 0x2000
    buffer_load_dwordx4 v[116:119], v7, s[44:47], s11 offen nt
    s_add_u32 s11, s11, 0x2000
    buffer_load_dwordx4 v[120:123], v7, s[44:47], s11 offen nt
    s_add_u32 s11, s11, 0x2000
    buffer_load_dwordx4 v[124:127], v7, s[44:47], s11 offen nt
    s_add_u32 s11, s11, 0x2000
    buffer_load_dwordx4 v[128:131], v7, s[44:47], s11 offen nt
    s_add_u32 s11, s11, 0x2000
    buffer_load_dwordx4 v[132:135], v7, s[44:47], s11 offen nt
    s_add_u32 s11, s11, 0x2000
    buffer_load_dwordx4 v[136:139], v7, s[44:47], s11 offen nt
    s_add_u32 s11, s11, 0x2000
    buffer_load_dwordx4 v[140:143], v7, s[44:47], s11 offen nt
    s_add_u32 s11, s11, 0x2000
    buffer_load_dwordx4 v[144:147], v7, s[44:47], s11 offen nt
    s_add_u32 s11, s11, 0x2000
    buffer_load_dwordx4 v[148:151], v7, s[44:47], s11 offen nt
    s_add_u32 s11, s11, 0x2000
    buffer_load_dwordx4 v[152:155], v7, s[44:47], s11 offen nt
    s_add_u32 s11, s11, 0x2000
    buffer_load_dwordx4 v[156:159], v7, s[44:47], s11 offen nt
    s_barrier
    s_mov_b32 s56, s38
    s_mov_b32 s57, s39
    s_mov_b32 s60, s36
    s_mov_b32 s61, s37
    s_lshl_b32 s98, s7, 10
    s_mov_b32 s101, 0
    s_waitcnt vmcnt(16)
    s_branch L_LN
L_W1:
    v_lshl_add_u32 v6, v4, 5, v6
    v_lshlrev_b32 v7, 6, v1
    s_lshr_b32 s10, s2, 3
    s_sub_u32 s11, 31, s10
    s_and_b32 s12, s2, 3
    s_lshl_b32 s12, s12, 4
    s_or_b32 s12, s12, 0x100000
    s_mov_b32 s64, 0x13202000
    s_mov_b32 s65, 0x14532033
    s_bitcmp1_b32 s2, 2
    s_cselect_b32 s64, 0x67a1367, s64
    s_cselect_b32 s65, 0x10a02080, s65
    s_bfe_u64 s[64:65], s[64:65], s12
    s_lshr_b32 s65, s64, 8
    s_and_b32 s64, s64, 0xff
    s_add_u32 s64, s64, s10
    s_mul_i32 s66, s64, 745
    s_lshr_b32 s66, s66, 14
    s_mul_i32 s67, s66, 175
    s_lshl_b32 s64, s64, 3
    s_sub_u32 s64, s64, s67
    s_cmp_lt_u32 s10, s65
    s_cselect_b32 s99, s64, 255
    s_mov_b32 s64, 0x61e1e00
    s_mov_b32 s65, 0xa442024
    s_bitcmp1_b32 s2, 2
    s_cselect_b32 s64, 0x4e004e, s64
    s_cselect_b32 s65, 0x580a4e, s65
    s_bfe_u64 s[64:65], s[64:65], s12
    s_lshr_b32 s65, s64, 8
    s_and_b32 s64, s64, 0xff
    s_add_u32 s64, s64, s11
    s_cmp_lt_u32 s11, s65
    s_cselect_b32 s96, s64, 255
    s_lshr_b32 s97, s96, 2
    s_and_b32 s96, s96, 3
    s_mul_i32 s100, s96, 22
    s_add_u32 s100, s100, s97
    s_lshl_b32 s100, s100, 10
    s_add_u32 s100, s100, 1048576
    s_lshl_b32 s98, s99, 10
    s_add_u32 s98, s98, 1179648
    s_and_b32 s12, s99, 7
    s_lshl_b32 s13, s12, 7
    s_waitcnt lgkmcnt(0)
    s_mov_b32 s60, s36
    s_mov_b32 s61, s37
    s_mov_b32 s40, s16
    s_mov_b32 s41, s17
    s_cmp_lg_u32 s2, 0
    s_cbranch_scc1 L_W1A
    s_mul_i32 s14, s14, 0x9e3779b1
    s_or_b32 s14, s14, 1
    s_mov_b32 s79, s14
    v_mov_b32 v160, s14
    s_mov_b64 exec, 15
    buffer_store_dword v160, v7, s[60:63], 0 offen sc1
    s_mov_b64 exec, -1
L_W1A:
    buffer_load_dwordx4 v[8:11], v5, s[40:43], 0 offen
    buffer_load_dwordx4 v[12:15], v5, s[40:43], 0 offen offset:16
    buffer_load_dwordx4 v[16:19], v6, s[40:43], s13 offen
    buffer_load_dwordx4 v[20:23], v6, s[40:43], s13 offen offset:16
    s_mov_b32 s44, s28
    s_mov_b32 s45, s29
    s_mov_b32 s46, 1409024
    s_mov_b32 s47, 0x20000
    s_mov_b32 s48, s30
    s_mov_b32 s49, s31
    s_mov_b32 s50, 1409024
    s_mov_b32 s51, 0x20000
    s_mov_b32 s56, s38
    s_mov_b32 s57, s39
    v_mul_u32_u24 v83, 44032, v4
    v_and_b32 v160, 7, v1
    v_lshl_add_u32 v83, v160, 4, v83
    s_mul_i32 s10, s12, 176128
    s_lshr_b32 s11, s99, 3
    s_lshl_b32 s11, s11, 7
    s_add_u32 s10, s10, s11
    s_mov_b32 s11, s10
    s_mov_b32 s14, 0x00ff00ff
    s_cmp_ge_u32 s99, 168
    s_cselect_b32 s14, 0x000f000f, s14
    s_mov_b32 s15, s14
    s_cmp_ge_u32 s99, 176
    s_cbranch_scc1 L_W1B
    s_mov_b32 s101, 1
    s_mov_b64 exec, s[14:15]
    buffer_load_dwordx4 v[96:99], v83, s[44:47], s10 offen nt
    s_add_u32 s10, s10, 2752
    buffer_load_dwordx4 v[100:103], v83, s[44:47], s10 offen nt
    s_add_u32 s10, s10, 2752
    buffer_load_dwordx4 v[104:107], v83, s[44:47], s10 offen nt
    s_add_u32 s10, s10, 2752
    buffer_load_dwordx4 v[108:111], v83, s[44:47], s10 offen nt
    s_add_u32 s10, s10, 2752
    buffer_load_dwordx4 v[112:115], v83, s[44:47], s10 offen nt
    s_add_u32 s10, s10, 2752
    buffer_load_dwordx4 v[116:119], v83, s[44:47], s10 offen nt
    s_add_u32 s10, s10, 2752
    buffer_load_dwordx4 v[120:123], v83, s[44:47], s10 offen nt
    s_add_u32 s10, s10, 2752
    buffer_load_dwordx4 v[124:127], v83, s[44:47], s10 offen nt
    s_add_u32 s10, s10, 2752
    buffer_load_dwordx4 v[128:131], v83, s[44:47], s10 offen nt
    s_add_u32 s10, s10, 2752
    buffer_load_dwordx4 v[132:135], v83, s[44:47], s10 offen nt
    s_add_u32 s10, s10, 2752
    buffer_load_dwordx4 v[136:139], v83, s[44:47], s10 offen nt
    s_add_u32 s10, s10, 2752
    buffer_load_dwordx4 v[140:143], v83, s[44:47], s10 offen nt
    s_add_u32 s10, s10, 2752
    buffer_load_dwordx4 v[144:147], v83, s[44:47], s10 offen nt
    s_add_u32 s10, s10, 2752
    buffer_load_dwordx4 v[148:151], v83, s[44:47], s10 offen nt
    s_add_u32 s10, s10, 2752
    buffer_load_dwordx4 v[152:155], v83, s[44:47], s10 offen nt
    s_add_u32 s10, s10, 2752
    buffer_load_dwordx4 v[156:159], v83, s[44:47], s10 offen nt
    s_lshl_b64 exec, s[14:15], 8
    buffer_load_dwordx4 v[96:99], v83, s[48:51], s11 offen nt
    s_add_u32 s11, s11, 2752
    buffer_load_dwordx4 v[100:103], v83, s[48:51], s11 offen nt
    s_add_u32 s11, s11, 2752
    buffer_load_dwordx4 v[104:107], v83, s[48:51], s11 offen nt
    s_add_u32 s11, s11, 2752
    buffer_load_dwordx4 v[108:111], v83, s[48:51], s11 offen nt
    s_add_u32 s11, s11, 2752
    buffer_load_dwordx4 v[112:115], v83, s[48:51], s11 offen nt
    s_add_u32 s11, s11, 2752
    buffer_load_dwordx4 v[116:119], v83, s[48:51], s11 offen nt
    s_add_u32 s11, s11, 2752
    buffer_load_dwordx4 v[120:123], v83, s[48:51], s11 offen nt
    s_add_u32 s11, s11, 2752
    buffer_load_dwordx4 v[124:127], v83, s[48:51], s11 offen nt
    s_add_u32 s11, s11, 2752
    buffer_load_dwordx4 v[128:131], v83, s[48:51], s11 offen nt
    s_add_u32 s11, s11, 2752
    buffer_load_dwordx4 v[132:135], v83, s[48:51], s11 offen nt
    s_add_u32 s11, s11, 2752
    buffer_load_dwordx4 v[136:139], v83, s[48:51], s11 offen nt
    s_add_u32 s11, s11, 2752
    buffer_load_dwordx4 v[140:143], v83, s[48:51], s11 offen nt
    s_add_u32 s11, s11, 2752
    buffer_load_dwordx4 v[144:147], v83, s[48:51], s11 offen nt
    s_add_u32 s11, s11, 2752
    buffer_load_dwordx4 v[148:151], v83, s[48:51], s11 offen nt
    s_add_u32 s11, s11, 2752
    buffer_load_dwordx4 v[152:155], v83, s[48:51], s11 offen nt
    s_add_u32 s11, s11, 2752
    buffer_load_dwordx4 v[156:159], v83, s[48:51], s11 offen nt
    s_mov_b64 exec, -1
    s_barrier
    s_waitcnt vmcnt(32)
    s_branch L_LN
L_W1B:
    s_mov_b32 s101, 3
    s_barrier
    s_cmp_lt_u32 s97, 22
    s_cbranch_scc1 L_W1C
    s_mov_b32 s101, 4
    s_waitcnt vmcnt(0)
    s_branch L_LN
L_W1C:
    s_mov_b32 s52, s32
    s_mov_b32 s53, s33
    s_mov_b32 s54, 1409024
    s_mov_b32 s55, 0x20000
    v_lshrrev_b32 v7, 4, v1
    v_lshl_add_u32 v7, v7, 14, v2
    s_lshl_b32 s10, s97, 16
    s_lshl_b32 s11, s96, 8
    s_add_u32 s10, s10, s11
    buffer_load_dwordx4 v[96:99], v7, s[52:55], s10 offen offset:0 nt
    buffer_load_dwordx4 v[100:103], v7, s[52:55], s10 offen offset:1024 nt
    buffer_load_dwordx4 v[104:107], v7, s[52:55], s10 offen offset:2048 nt
    buffer_load_dwordx4 v[108:111], v7, s[52:55], s10 offen offset:3072 nt
    s_add_u32 s10, s10, 0x1000
    buffer_load_dwordx4 v[112:115], v7, s[52:55], s10 offen offset:0 nt
    buffer_load_dwordx4 v[116:119], v7, s[52:55], s10 offen offset:1024 nt
    buffer_load_dwordx4 v[120:123], v7, s[52:55], s10 offen offset:2048 nt
    buffer_load_dwordx4 v[124:127], v7, s[52:55], s10 offen offset:3072 nt
    s_add_u32 s10, s10, 0x1000
    buffer_load_dwordx4 v[128:131], v7, s[52:55], s10 offen offset:0 nt
    buffer_load_dwordx4 v[132:135], v7, s[52:55], s10 offen offset:1024 nt
    buffer_load_dwordx4 v[136:139], v7, s[52:55], s10 offen offset:2048 nt
    buffer_load_dwordx4 v[140:143], v7, s[52:55], s10 offen offset:3072 nt
    s_add_u32 s10, s10, 0x1000
    buffer_load_dwordx4 v[144:147], v7, s[52:55], s10 offen offset:0 nt
    buffer_load_dwordx4 v[148:151], v7, s[52:55], s10 offen offset:1024 nt
    buffer_load_dwordx4 v[152:155], v7, s[52:55], s10 offen offset:2048 nt
    buffer_load_dwordx4 v[156:159], v7, s[52:55], s10 offen offset:3072 nt
    s_waitcnt vmcnt(16)
L_LN:
    s_mov_b32 s76, 0
    v_mov_b32 v5, 0x3f803f80
    v_mov_b32 v6, 0
    v_dot2c_f32_bf16 v6, v8, v5
    v_dot2c_f32_bf16 v6, v9, v5
    v_dot2c_f32_bf16 v6, v10, v5
    v_dot2c_f32_bf16 v6, v11, v5
    v_dot2c_f32_bf16 v6, v12, v5
    v_dot2c_f32_bf16 v6, v13, v5
    v_dot2c_f32_bf16 v6, v14, v5
    v_dot2c_f32_bf16 v6, v15, v5
    v_bfe_u32 v7, v1, 1, 2
    v_lshlrev_b32 v160, 4, v1
    v_and_b32 v160, 16, v160
    v_mov_b32 v161, 0x0c0c0100
    v_mov_b32 v162, 0x0c0c0302
    v_alignbit_b32 v161, v161, v161, v160
    v_alignbit_b32 v162, v162, v162, v160
    v_mov_b32 v163, 0x0c0c0c0c
    v_add_f32_dpp v6, v6, v6 quad_perm:[1,0,3,2] row_mask:0xf bank_mask:0xf
    s_nop 1
    v_add_f32_dpp v6, v6, v6 quad_perm:[2,3,0,1] row_mask:0xf bank_mask:0xf
    s_nop 1
    v_add_f32_dpp v6, v6, v6 row_half_mirror row_mask:0xf bank_mask:0xf
    v_mov_b32 v5, v6
    s_nop 1
    v_permlane16_swap_b32 v6, v5
    v_add_f32 v6, v6, v5
    v_mov_b32 v5, v6
    s_nop 1
    v_permlane32_swap_b32 v6, v5
    v_add_f32 v6, v6, v5
    v_cmp_eq_u32 vcc, 0, v7
    s_nop 1
    v_cndmask_b32 v24, v163, v161, vcc
    v_cndmask_b32 v28, v163, v162, vcc
    v_cmp_eq_u32 vcc, 1, v7
    s_nop 1
    v_cndmask_b32 v25, v163, v161, vcc
    v_cndmask_b32 v29, v163, v162, vcc
    v_cmp_eq_u32 vcc, 2, v7
    s_nop 1
    v_cndmask_b32 v26, v163, v161, vcc
    v_cndmask_b32 v30, v163, v162, vcc
    v_cmp_eq_u32 vcc, 3, v7
    s_nop 1
    v_cndmask_b32 v27, v163, v161, vcc
    v_cndmask_b32 v31, v163, v162, vcc
    v_mul_f32 v6, 0xbb000000, v6
    v_mov_b32 v164, 0
    v_mov_b32 v165, 0
    v_lshlrev_b32 v160, 16, v8
    v_and_b32 v161, 0xffff0000, v8
    v_pk_add_f32 v[160:161], v[160:161], v[6:7] op_sel_hi:[1,0]
    v_pk_fma_f32 v[164:165], v[160:161], v[160:161], v[164:165]
    v_lshlrev_b32 v162, 16, v9
    v_and_b32 v163, 0xffff0000, v9
    v_pk_add_f32 v[162:163], v[162:163], v[6:7] op_sel_hi:[1,0]
    v_pk_fma_f32 v[164:165], v[162:163], v[162:163], v[164:165]
    v_lshlrev_b32 v160, 16, v10
    v_and_b32 v161, 0xffff0000, v10
    v_pk_add_f32 v[160:161], v[160:161], v[6:7] op_sel_hi:[1,0]
    v_pk_fma_f32 v[164:165], v[160:161], v[160:161], v[164:165]
    v_lshlrev_b32 v162, 16, v11
    v_and_b32 v163, 0xffff0000, v11
    v_pk_add_f32 v[162:163], v[162:163], v[6:7] op_sel_hi:[1,0]
    v_pk_fma_f32 v[164:165], v[162:163], v[162:163], v[164:165]
    v_lshlrev_b32 v160, 16, v12
    v_and_b32 v161, 0xffff0000, v12
    v_pk_add_f32 v[160:161], v[160:161], v[6:7] op_sel_hi:[1,0]
    v_pk_fma_f32 v[164:165], v[160:161], v[160:161], v[164:165]
    v_lshlrev_b32 v162, 16, v13
    v_and_b32 v163, 0xffff0000, v13
    v_pk_add_f32 v[162:163], v[162:163], v[6:7] op_sel_hi:[1,0]
    v_pk_fma_f32 v[164:165], v[162:163], v[162:163], v[164:165]
    v_lshlrev_b32 v160, 16, v14
    v_and_b32 v161, 0xffff0000, v14
    v_pk_add_f32 v[160:161], v[160:161], v[6:7] op_sel_hi:[1,0]
    v_pk_fma_f32 v[164:165], v[160:161], v[160:161], v[164:165]
    v_lshlrev_b32 v162, 16, v15
    v_and_b32 v163, 0xffff0000, v15
    v_pk_add_f32 v[162:163], v[162:163], v[6:7] op_sel_hi:[1,0]
    v_pk_fma_f32 v[164:165], v[162:163], v[162:163], v[164:165]
    v_add_f32 v164, v164, v165
    s_mov_b32 s77, 0
    s_nop 0
    v_add_f32_dpp v164, v164, v164 quad_perm:[1,0,3,2] row_mask:0xf bank_mask:0xf
    s_nop 1
    v_add_f32_dpp v164, v164, v164 quad_perm:[2,3,0,1] row_mask:0xf bank_mask:0xf
    s_nop 1
    v_add_f32_dpp v164, v164, v164 row_half_mirror row_mask:0xf bank_mask:0xf
    v_mov_b32 v165, v164
    s_nop 1
    v_permlane16_swap_b32 v164, v165
    v_add_f32 v164, v164, v165
    v_mov_b32 v165, v164
    s_nop 1
    v_permlane32_swap_b32 v164, v165
    v_add_f32 v164, v164, v165
    v_mul_f32 v164, 0x3b000000, v164
    v_cvt_pk_bf16_f32 v164, v164, v164
    v_lshlrev_b32 v164, 16, v164
    v_add_f32 v164, 0x3727c5ac, v164
    v_cvt_pk_bf16_f32 v164, v164, v164
    v_lshlrev_b32 v164, 16, v164
    v_sqrt_f32 v164, v164
    v_cvt_pk_bf16_f32 v6, v6, v6
    v_lshlrev_b32 v6, 16, v6
    v_cvt_pk_bf16_f32 v164, v164, v164
    v_lshlrev_b32 v164, 16, v164
    v_rcp_f32 v164, v164
    v_lshlrev_b32 v160, 16, v16
    v_and_b32 v161, 0xffff0000, v16
    v_pk_add_f32 v[160:161], v[160:161], v[6:7] op_sel_hi:[1,0]
    v_cvt_pk_bf16_f32 v160, v160, v161
    v_and_b32 v161, 0xffff0000, v160
    v_lshlrev_b32 v160, 16, v160
    v_pk_mul_f32 v[160:161], v[160:161], v[164:165] op_sel_hi:[1,0]
    v_cvt_pk_bf16_f32 v16, v160, v161
    v_lshlrev_b32 v162, 16, v17
    v_and_b32 v163, 0xffff0000, v17
    v_pk_add_f32 v[162:163], v[162:163], v[6:7] op_sel_hi:[1,0]
    v_cvt_pk_bf16_f32 v162, v162, v163
    v_and_b32 v163, 0xffff0000, v162
    v_lshlrev_b32 v162, 16, v162
    v_pk_mul_f32 v[162:163], v[162:163], v[164:165] op_sel_hi:[1,0]
    v_cvt_pk_bf16_f32 v17, v162, v163
    v_lshlrev_b32 v160, 16, v18
    v_and_b32 v161, 0xffff0000, v18
    v_pk_add_f32 v[160:161], v[160:161], v[6:7] op_sel_hi:[1,0]
    v_cvt_pk_bf16_f32 v160, v160, v161
    v_and_b32 v161, 0xffff0000, v160
    v_lshlrev_b32 v160, 16, v160
    v_pk_mul_f32 v[160:161], v[160:161], v[164:165] op_sel_hi:[1,0]
    v_cvt_pk_bf16_f32 v18, v160, v161
    v_lshlrev_b32 v162, 16, v19
    v_and_b32 v163, 0xffff0000, v19
    v_pk_add_f32 v[162:163], v[162:163], v[6:7] op_sel_hi:[1,0]
    v_cvt_pk_bf16_f32 v162, v162, v163
    v_and_b32 v163, 0xffff0000, v162
    v_lshlrev_b32 v162, 16, v162
    v_pk_mul_f32 v[162:163], v[162:163], v[164:165] op_sel_hi:[1,0]
    v_cvt_pk_bf16_f32 v19, v162, v163
    v_lshlrev_b32 v160, 16, v20
    v_and_b32 v161, 0xffff0000, v20
    v_pk_add_f32 v[160:161], v[160:161], v[6:7] op_sel_hi:[1,0]
    v_cvt_pk_bf16_f32 v160, v160, v161
    v_and_b32 v161, 0xffff0000, v160
    v_lshlrev_b32 v160, 16, v160
    v_pk_mul_f32 v[160:161], v[160:161], v[164:165] op_sel_hi:[1,0]
    v_cvt_pk_bf16_f32 v20, v160, v161
    v_lshlrev_b32 v162, 16, v21
    v_and_b32 v163, 0xffff0000, v21
    v_pk_add_f32 v[162:163], v[162:163], v[6:7] op_sel_hi:[1,0]
    v_cvt_pk_bf16_f32 v162, v162, v163
    v_and_b32 v163, 0xffff0000, v162
    v_lshlrev_b32 v162, 16, v162
    v_pk_mul_f32 v[162:163], v[162:163], v[164:165] op_sel_hi:[1,0]
    v_cvt_pk_bf16_f32 v21, v162, v163
    v_lshlrev_b32 v160, 16, v22
    v_and_b32 v161, 0xffff0000, v22
    v_pk_add_f32 v[160:161], v[160:161], v[6:7] op_sel_hi:[1,0]
    v_cvt_pk_bf16_f32 v160, v160, v161
    v_and_b32 v161, 0xffff0000, v160
    v_lshlrev_b32 v160, 16, v160
    v_pk_mul_f32 v[160:161], v[160:161], v[164:165] op_sel_hi:[1,0]
    v_cvt_pk_bf16_f32 v22, v160, v161
    v_lshlrev_b32 v162, 16, v23
    v_and_b32 v163, 0xffff0000, v23
    v_pk_add_f32 v[162:163], v[162:163], v[6:7] op_sel_hi:[1,0]
    v_cvt_pk_bf16_f32 v162, v162, v163
    v_and_b32 v163, 0xffff0000, v162
    v_lshlrev_b32 v162, 16, v162
    v_pk_mul_f32 v[162:163], v[162:163], v[164:165] op_sel_hi:[1,0]
    v_cvt_pk_bf16_f32 v23, v162, v163
    s_load_dword s78, s[36:37], 128
    v_lshlrev_b32 v3, 5, v3
    v_and_b32 v5, 16, v1
    v_add_u32 v3, v3, v5
    v_lshrrev_b32 v5, 5, v1
    v_lshl_add_u32 v3, v5, 9, v3
    v_mov_b32 v0, 0xfffffc00
    s_cmp_lt_u32 s101, 3
    s_cbranch_scc1 L_B16
    s_waitcnt vmcnt(8) lgkmcnt(0)
    s_or_b32 s76, s76, s77
    s_or_b32 s76, s76, s78
    s_cbranch_scc1 L_GT
    s_load_dword s76, s[36:37], 192
    s_branch L_GT
L_B16:
    v_mov_b32 v4, 0
    v_mov_b32 v5, 0
    v_mov_b32 v6, 0
    v_mov_b32 v7, 0
    v_perm_b32 v160, v16, v16, v24
    v_perm_b32 v161, v16, v16, v25
    v_perm_b32 v162, v16, v16, v26
    v_perm_b32 v163, v16, v16, v27
    s_waitcnt vmcnt(15)
    s_nop 0
    v_mfma_f32_16x16x32_bf16 v[4:7], v[160:163], v[96:99], v[4:7]
    v_perm_b32 v164, v16, v16, v28
    v_perm_b32 v165, v16, v16, v29
    v_perm_b32 v166, v16, v16, v30
    v_perm_b32 v167, v16, v16, v31
    s_waitcnt vmcnt(14)
    s_nop 0
    v_mfma_f32_16x16x32_bf16 v[4:7], v[164:167], v[100:103], v[4:7]
    v_perm_b32 v160, v17, v17, v24
    v_perm_b32 v161, v17, v17, v25
    v_perm_b32 v162, v17, v17, v26
    v_perm_b32 v163, v17, v17, v27
    s_waitcnt vmcnt(13)
    s_nop 0
    v_mfma_f32_16x16x32_bf16 v[4:7], v[160:163], v[104:107], v[4:7]
    v_perm_b32 v164, v17, v17, v28
    v_perm_b32 v165, v17, v17, v29
    v_perm_b32 v166, v17, v17, v30
    v_perm_b32 v167, v17, v17, v31
    s_waitcnt vmcnt(12)
    s_nop 0
    v_mfma_f32_16x16x32_bf16 v[4:7], v[164:167], v[108:111], v[4:7]
    v_perm_b32 v160, v18, v18, v24
    v_perm_b32 v161, v18, v18, v25
    v_perm_b32 v162, v18, v18, v26
    v_perm_b32 v163, v18, v18, v27
    s_waitcnt vmcnt(11)
    s_nop 0
    v_mfma_f32_16x16x32_bf16 v[4:7], v[160:163], v[112:115], v[4:7]
    v_perm_b32 v164, v18, v18, v28
    v_perm_b32 v165, v18, v18, v29
    v_perm_b32 v166, v18, v18, v30
    v_perm_b32 v167, v18, v18, v31
    s_waitcnt vmcnt(10)
    s_nop 0
    v_mfma_f32_16x16x32_bf16 v[4:7], v[164:167], v[116:119], v[4:7]
    v_perm_b32 v160, v19, v19, v24
    v_perm_b32 v161, v19, v19, v25
    v_perm_b32 v162, v19, v19, v26
    v_perm_b32 v163, v19, v19, v27
    s_waitcnt vmcnt(9)
    s_waitcnt lgkmcnt(0)
    s_or_b32 s76, s76, s77
    s_or_b32 s76, s76, s78
    s_cbranch_scc1 L_B16T
    s_load_dword s76, s[36:37], 192
L_B16T:
    v_mfma_f32_16x16x32_bf16 v[4:7], v[160:163], v[120:123], v[4:7]
    v_perm_b32 v164, v19, v19, v28
    v_perm_b32 v165, v19, v19, v29
    v_perm_b32 v166, v19, v19, v30
    v_perm_b32 v167, v19, v19, v31
    s_waitcnt vmcnt(8)
    s_nop 0
    v_mfma_f32_16x16x32_bf16 v[4:7], v[164:167], v[124:127], v[4:7]
    v_perm_b32 v160, v20, v20, v24
    v_perm_b32 v161, v20, v20, v25
    v_perm_b32 v162, v20, v20, v26
    v_perm_b32 v163, v20, v20, v27
    s_waitcnt vmcnt(7)
    s_nop 0
    v_mfma_f32_16x16x32_bf16 v[4:7], v[160:163], v[128:131], v[4:7]
    v_perm_b32 v164, v20, v20, v28
    v_perm_b32 v165, v20, v20, v29
    v_perm_b32 v166, v20, v20, v30
    v_perm_b32 v167, v20, v20, v31
    s_waitcnt vmcnt(6)
    s_nop 0
    v_mfma_f32_16x16x32_bf16 v[4:7], v[164:167], v[132:135], v[4:7]
    v_perm_b32 v160, v21, v21, v24
    v_perm_b32 v161, v21, v21, v25
    v_perm_b32 v162, v21, v21, v26
    v_perm_b32 v163, v21, v21, v27
    s_waitcnt vmcnt(5)
    s_nop 0
    v_mfma_f32_16x16x32_bf16 v[4:7], v[160:163], v[136:139], v[4:7]
    v_perm_b32 v164, v21, v21, v28
    v_perm_b32 v165, v21, v21, v29
    v_perm_b32 v166, v21, v21, v30
    v_perm_b32 v167, v21, v21, v31
    s_waitcnt vmcnt(4)
    s_nop 0
    v_mfma_f32_16x16x32_bf16 v[4:7], v[164:167], v[140:143], v[4:7]
    v_perm_b32 v160, v22, v22, v24
    v_perm_b32 v161, v22, v22, v25
    v_perm_b32 v162, v22, v22, v26
    v_perm_b32 v163, v22, v22, v27
    s_waitcnt vmcnt(3)
    s_nop 0
    v_mfma_f32_16x16x32_bf16 v[4:7], v[160:163], v[144:147], v[4:7]
    v_perm_b32 v164, v22, v22, v28
    v_perm_b32 v165, v22, v22, v29
    v_perm_b32 v166, v22, v22, v30
    v_perm_b32 v167, v22, v22, v31
    s_waitcnt vmcnt(2)
    s_nop 0
    v_mfma_f32_16x16x32_bf16 v[4:7], v[164:167], v[148:151], v[4:7]
    v_perm_b32 v160, v23, v23, v24
    v_perm_b32 v161, v23, v23, v25
    v_perm_b32 v162, v23, v23, v26
    v_perm_b32 v163, v23, v23, v27
    s_waitcnt vmcnt(1)
    s_nop 0
    v_mfma_f32_16x16x32_bf16 v[4:7], v[160:163], v[152:155], v[4:7]
    v_perm_b32 v164, v23, v23, v28
    v_perm_b32 v165, v23, v23, v29
    v_perm_b32 v166, v23, v23, v30
    v_perm_b32 v167, v23, v23, v31
    s_waitcnt vmcnt(0)
    s_nop 0
    v_mfma_f32_16x16x32_bf16 v[4:7], v[164:167], v[156:159], v[4:7]
    s_cmp_eq_u32 s101, 2
    s_cbranch_scc1 L_BF
L_GT:
    s_waitcnt lgkmcnt(0)
    s_or_b32 s76, s76, s77
    s_or_b32 s76, s76, s78
    s_cbranch_scc1 L_TKA
L_TPA:
    buffer_load_dword v160, off, s[60:63], 0 sc1
    s_sub_u32 s9, s9, 32
    s_cbranch_scc1 L_END
    s_waitcnt vmcnt(0)
    v_readfirstlane_b32 s76, v160
    s_cmp_eq_u32 s76, 0
    s_cbranch_scc1 L_TPA
L_TKA:
    s_bfe_u32 s64, s76, 524288
    s_or_b32 s72, s64, 0x300
    s_or_b32 s64, s64, 0x100
    s_bfe_u32 s65, s76, 524296
    s_or_b32 s73, s65, 0x300
    s_or_b32 s65, s65, 0x100
    s_bfe_u32 s66, s76, 524304
    s_or_b32 s74, s66, 0x300
    s_or_b32 s66, s66, 0x100
    s_bfe_u32 s67, s76, 524312
    s_or_b32 s75, s67, 0x300
    s_or_b32 s67, s67, 0x100
    s_getreg_b32 s79, hwreg(HW_REG_XCC_ID, 0, 4)
    s_or_b32 s79, s79, 0x100
    v_and_b32 v8, 16, v1
    v_lshlrev_b32 v12, 4, v1
    v_and_b32 v12, 16, v12
    v_lshrrev_b32 v8, v8, s76
    v_lshrrev_b32 v12, v12, s76
    v_lshrrev_b32 v11, 12, v8
    v_bfe_u32 v15, v12, 12, 4
    v_lshrrev_b32 v10, 8, v8
    v_bfe_u32 v14, v12, 8, 4
    v_lshrrev_b32 v9, 4, v8
    v_bfe_u32 v13, v12, 4, 4
    v_and_b32 v12, 15, v12
    v_or_b32 v8, 16, v8
    v_or_b32 v9, 16, v9
    v_or_b32 v10, 16, v10
    v_or_b32 v11, 16, v11
    s_cmp_eq_u32 s101, 3
    s_cbranch_scc1 L_S2
    s_cmp_eq_u32 s101, 4
    s_cbranch_scc1 L_S2X
    v_bfi_b32 v4, 31, v8, v4
    v_bfi_b32 v5, 31, v9, v5
    v_bfi_b32 v6, 31, v10, v6
    v_bfi_b32 v7, 31, v11, v7
    s_cmp_lg_u32 s101, 0
    s_cbranch_scc1 L_NP
    s_xor_b32 s10, s76, 0x80000000
    s_xor_b32 s10, s10, s79
    v_mov_b32 v16, 0
    v_mov_b32 v17, 0
    v_mov_b32 v18, 0
    v_mov_b32 v19, 0
    v_lshlrev_b32 v20, 4, v1
    s_lshl_b32 s11, s7, 10
    s_add_u32 s11, s11, 1835008
    s_mov_b32 exec_lo, 0
    v_mov_b32 v18, s10
    v_mov_b32 v19, s10
    s_mov_b32 exec_lo, -1
    s_mov_b32 exec_hi, 0xff
    buffer_store_dwordx4 v[16:19], v20, s[56:59], s11 offen
    s_mov_b64 exec, -1
L_NP:
    buffer_store_dwordx4 v[4:7], v3, s[56:59], s98 offen sc1
    s_cmp_eq_u32 s101, 1
    s_cbranch_scc1 L_S1X
    v_lshrrev_b32 v9, 5, v1
    v_and_b32 v10, 31, v1
    v_lshlrev_b32 v11, 4, v10
    v_lshl_add_u32 v11, v9, 10, v11
    s_lshl_b32 s12, s4, 13
    s_lshl_b32 s13, s5, 9
    s_add_u32 s12, s12, s13
    s_add_u32 s13, s12, 0x1000
    s_mov_b64 s[16:17], -1
    s_mov_b64 s[18:19], -1
    s_mov_b64 s[20:21], -1
    s_mov_b64 s[22:23], -1
    v_mov_b32 v8, 0
    s_waitcnt vmcnt(0)
L_W0Q:
    s_mov_b64 exec, s[16:17]
    s_cbranch_execz L_W0Q0
    buffer_load_dwordx4 v[32:35], v11, s[56:59], s12 offen offset:0 sc1
L_W0Q0:
    s_mov_b64 exec, s[18:19]
    s_cbranch_execz L_W0Q1
    buffer_load_dwordx4 v[36:39], v11, s[56:59], s12 offen offset:2048 sc1
L_W0Q1:
    s_mov_b64 exec, s[20:21]
    s_cbranch_execz L_W0Q2
    buffer_load_dwordx4 v[40:43], v11, s[56:59], s13 offen offset:0 sc1
L_W0Q2:
    s_mov_b64 exec, s[22:23]
    s_cbranch_execz L_W0Q3
    buffer_load_dwordx4 v[44:47], v11, s[56:59], s13 offen offset:2048 sc1
L_W0Q3:
    s_sub_u32 s9, s9, 32
    s_cbranch_scc1 L_END
    s_waitcnt vmcnt(0)
    s_mov_b64 exec, s[16:17]
    v_xor_b32 v32, v12, v32
    v_xor_b32 v33, v13, v33
    v_xor_b32 v34, v14, v34
    v_xor_b32 v35, v15, v35
    v_or3_b32 v16, v32, v33, v34
    v_or_b32 v16, v16, v35
    v_and_b32 v16, 15, v16
    v_cmp_ne_u32 vcc, 0, v16
    s_cmp_lg_u32 vcc_lo, 0
    s_cselect_b32 s16, -1, 0
    s_cmp_lg_u32 vcc_hi, 0
    s_cselect_b32 s17, -1, 0
    s_mov_b64 exec, s[18:19]
    v_xor_b32 v36, v12, v36
    v_xor_b32 v37, v13, v37
    v_xor_b32 v38, v14, v38
    v_xor_b32 v39, v15, v39
    v_or3_b32 v16, v36, v37, v38
    v_or_b32 v16, v16, v39
    v_and_b32 v16, 15, v16
    v_cmp_ne_u32 vcc, 0, v16
    s_cmp_lg_u32 vcc_lo, 0
    s_cselect_b32 s18, -1, 0
    s_cmp_lg_u32 vcc_hi, 0
    s_cselect_b32 s19, -1, 0
    s_mov_b64 exec, s[20:21]
    v_xor_b32 v40, v12, v40
    v_xor_b32 v41, v13, v41
    v_xor_b32 v42, v14, v42
    v_xor_b32 v43, v15, v43
    v_or3_b32 v16, v40, v41, v42
    v_or_b32 v16, v16, v43
    v_and_b32 v16, 15, v16
    v_cmp_ne_u32 vcc, 0, v16
    s_cmp_lg_u32 vcc_lo, 0
    s_cselect_b32 s20, -1, 0
    s_cmp_lg_u32 vcc_hi, 0
    s_cselect_b32 s21, -1, 0
    s_mov_b64 exec, s[22:23]
    v_xor_b32 v44, v12, v44
    v_xor_b32 v45, v13, v45
    v_xor_b32 v46, v14, v46
    v_xor_b32 v47, v15, v47
    v_or3_b32 v16, v44, v45, v46
    v_or_b32 v16, v16, v47
    v_and_b32 v16, 15, v16
    v_cmp_ne_u32 vcc, 0, v16
    s_cmp_lg_u32 vcc_lo, 0
    s_cselect_b32 s22, -1, 0
    s_cmp_lg_u32 vcc_hi, 0
    s_cselect_b32 s23, -1, 0
    s_or_b64 s[14:15], s[16:17], s[18:19]
    s_or_b64 s[10:11], s[20:21], s[22:23]
    s_or_b64 s[14:15], s[14:15], s[10:11]
    s_cbranch_scc1 L_W0Q
    s_mov_b64 exec, -1
    v_pk_add_f32 v[32:33], v[32:33], v[36:37]
    v_pk_add_f32 v[34:35], v[34:35], v[38:39]
    v_pk_add_f32 v[40:41], v[40:41], v[44:45]
    v_pk_add_f32 v[42:43], v[42:43], v[46:47]
    v_pk_add_f32 v[32:33], v[32:33], v[40:41]
    v_pk_add_f32 v[34:35], v[34:35], v[42:43]
    v_lshlrev_b32 v10, 3, v10
    v_lshl_add_u32 v10, v9, 2, v10
    v_permlane32_swap_b32 v32, v34
    v_permlane32_swap_b32 v33, v35
    v_pk_add_f32 v[32:33], v[32:33], v[34:35]
    v_mov_b32 v9, s76
    v_cvt_pk_bf16_f32 v32, v32, v33
    ds_write_b32 v10, v32 offset:256
    s_mov_b64 exec, 1
    ds_write_b32 v8, v9 offset:4
    s_mov_b64 exec, -1
    s_mov_b32 s68, s34
    s_mov_b32 s69, s35
    s_mov_b32 s70, 2048
    s_mov_b32 s71, 0x20000
    s_and_b32 s99, s2, 0xc0
    s_and_b32 s10, s2, 7
    s_lshl_b32 s10, s10, 3
    s_or_b32 s99, s99, s10
    s_bfe_u32 s10, s2, 0x30003
    s_or_b32 s99, s99, s10
    s_bfe_u32 s10, s99, 0x20005
    s_and_b32 s11, s99, 31
    s_lshl_b32 s11, s11, 4
    s_lshr_b32 s12, s99, 7
    s_lshl_b32 s12, s12, 9
    s_add_u32 s11, s11, s12
    s_mul_i32 s12, s10, 22528
    s_add_u32 s12, s12, s11
    s_add_u32 s98, s12, 1048576
    s_lshl_b32 s96, s10, 10
    s_add_u32 s96, s96, s11
    s_add_u32 s96, s96, 589824
    s_mul_i32 s97, s10, 4096
    s_bfe_u32 s12, s11, 0x30005
    s_lshl_b32 s12, s12, 3
    s_add_u32 s97, s97, s12
    s_bfe_u32 s12, s11, 0x10008
    s_mul_i32 s12, s12, 128
    s_add_u32 s97, s97, s12
    s_bfe_u32 s12, s11, 0x10004
    s_mul_i32 s12, s12, 256
    s_add_u32 s97, s97, s12
    s_bfe_u32 s12, s11, 0x10009
    s_mul_i32 s12, s12, 512
    s_add_u32 s97, s97, s12
    s_add_u32 s97, s97, 524288
    s_lshl_b32 s99, s6, 8
    v_and_b32 v64, 0x1ff, v3
    v_lshrrev_b32 v64, 1, v64
    v_lshrrev_b32 v65, 9, v3
    v_lshl_add_u32 v64, v65, 10, v64
    v_lshlrev_b32 v65, 10, v1
    v_and_b32 v9, 7, v1
    v_lshlrev_b32 v9, 3, v9
    s_lshl_b32 s10, s7, 10
    s_add_u32 s10, s10, 1572864
    s_add_u32 s11, s10, 262144
    v_mov_b32 v16, s76
    v_mov_b32 v17, s76
    s_xor_b32 s12, s76, s79
    v_mov_b32 v86, s12
    v_mov_b32 v87, s12
L_W0M:
    ds_read_b32 v11, v8 offset:8
    ds_read_b64 v[12:13], v9 offset:64
    s_sub_u32 s9, s9, 1
    s_cbranch_scc1 L_END
    s_waitcnt lgkmcnt(0)
    v_readfirstlane_b32 s12, v11
    s_cmp_lg_u32 s12, 8
    s_cbranch_scc1 L_W0M
    v_max_f32_dpp v14, v12, v12 quad_perm:[1,0,3,2] row_mask:0xf bank_mask:0xf
    s_nop 1
    v_max_f32_dpp v14, v14, v14 quad_perm:[2,3,0,1] row_mask:0xf bank_mask:0xf
    s_nop 1
    v_max_f32_dpp v14, v14, v14 row_half_mirror row_mask:0xf bank_mask:0xf
    v_sub_f32 v12, v12, v14
    v_mul_f32 v12, 0x3fb8aa3b, v12
    v_exp_f32 v12, v12
    v_mov_b32 v84, v14
    v_mul_f32 v15, v12, v13
    s_nop 1
    v_add_f32_dpp v15, v15, v15 quad_perm:[1,0,3,2] row_mask:0xf bank_mask:0xf
    s_nop 1
    v_add_f32_dpp v15, v15, v15 quad_perm:[2,3,0,1] row_mask:0xf bank_mask:0xf
    s_nop 1
    v_add_f32_dpp v85, v15, v15 row_half_mirror row_mask:0xf bank_mask:0xf
    v_add_f32_dpp v15, v15, v15 row_half_mirror row_mask:0xf bank_mask:0xf
    s_mov_b64 exec, 1
    buffer_store_dwordx4 v[84:87], off, s[56:59], s11 offset:512
    buffer_store_dwordx4 v[14:17], off, s[56:59], s10 offset:512 sc1
    s_mov_b64 exec, -1
    s_branch L_TAIL
L_BF:
    s_nop 5
    v_and_or_b32 v4, v4, v0, s72
    v_and_or_b32 v5, v5, v0, s73
    v_and_or_b32 v6, v6, v0, s74
    v_and_or_b32 v7, v7, v0, s75
    buffer_store_dwordx4 v[4:7], v3, s[56:59], s100 offen sc1
    s_branch L_S2X
L_S1X:
    s_cmp_ge_u32 s97, 22
    s_cbranch_scc1 L_S2X
    s_mov_b32 s52, s32
    s_mov_b32 s53, s33
    s_mov_b32 s54, 1409024
    s_mov_b32 s55, 0x20000
    v_lshrrev_b32 v7, 4, v1
    v_lshl_add_u32 v7, v7, 14, v2
    s_lshl_b32 s10, s97, 16
    s_lshl_b32 s11, s96, 8
    s_add_u32 s10, s10, s11
    buffer_load_dwordx4 v[96:99], v7, s[52:55], s10 offen offset:0 nt
    buffer_load_dwordx4 v[100:103], v7, s[52:55], s10 offen offset:1024 nt
    buffer_load_dwordx4 v[104:107], v7, s[52:55], s10 offen offset:2048 nt
    buffer_load_dwordx4 v[108:111], v7, s[52:55], s10 offen offset:3072 nt
    s_add_u32 s10, s10, 0x1000
    buffer_load_dwordx4 v[112:115], v7, s[52:55], s10 offen offset:0 nt
    buffer_load_dwordx4 v[116:119], v7, s[52:55], s10 offen offset:1024 nt
    buffer_load_dwordx4 v[120:123], v7, s[52:55], s10 offen offset:2048 nt
    buffer_load_dwordx4 v[124:127], v7, s[52:55], s10 offen offset:3072 nt
    s_add_u32 s10, s10, 0x1000
    buffer_load_dwordx4 v[128:131], v7, s[52:55], s10 offen offset:0 nt
    buffer_load_dwordx4 v[132:135], v7, s[52:55], s10 offen offset:1024 nt
    buffer_load_dwordx4 v[136:139], v7, s[52:55], s10 offen offset:2048 nt
    buffer_load_dwordx4 v[140:143], v7, s[52:55], s10 offen offset:3072 nt
    s_add_u32 s10, s10, 0x1000
    buffer_load_dwordx4 v[144:147], v7, s[52:55], s10 offen offset:0 nt
    buffer_load_dwordx4 v[148:151], v7, s[52:55], s10 offen offset:1024 nt
    buffer_load_dwordx4 v[152:155], v7, s[52:55], s10 offen offset:2048 nt
    buffer_load_dwordx4 v[156:159], v7, s[52:55], s10 offen offset:3072 nt
L_S2:
    v_lshlrev_b32 v4, 4, v1
    s_lshl_b32 s10, s97, 13
    s_add_u32 s10, s10, 1179648
    s_add_u32 s11, s10, 0x1000
    s_movk_i32 s12, 0xff
    s_mov_b32 s101, 2
    s_waitcnt vmcnt(0)
L_W1E:
    s_bitcmp1_b32 s12, 0
    s_cbranch_scc0 L_W1E0
    buffer_load_dwordx4 v[32:35], v4, s[56:59], s10 offen offset:0 sc1
L_W1E0:
    s_bitcmp1_b32 s12, 1
    s_cbranch_scc0 L_W1E1
    buffer_load_dwordx4 v[36:39], v4, s[56:59], s10 offen offset:1024 sc1
L_W1E1:
    s_bitcmp1_b32 s12, 2
    s_cbranch_scc0 L_W1E2
    buffer_load_dwordx4 v[40:43], v4, s[56:59], s10 offen offset:2048 sc1
L_W1E2:
    s_bitcmp1_b32 s12, 3
    s_cbranch_scc0 L_W1E3
    buffer_load_dwordx4 v[44:47], v4, s[56:59], s10 offen offset:3072 sc1
L_W1E3:
    s_bitcmp1_b32 s12, 4
    s_cbranch_scc0 L_W1E4
    buffer_load_dwordx4 v[48:51], v4, s[56:59], s11 offen offset:0 sc1
L_W1E4:
    s_bitcmp1_b32 s12, 5
    s_cbranch_scc0 L_W1E5
    buffer_load_dwordx4 v[52:55], v4, s[56:59], s11 offen offset:1024 sc1
L_W1E5:
    s_bitcmp1_b32 s12, 6
    s_cbranch_scc0 L_W1E6
    buffer_load_dwordx4 v[56:59], v4, s[56:59], s11 offen offset:2048 sc1
L_W1E6:
    s_bitcmp1_b32 s12, 7
    s_cbranch_scc0 L_W1E7
    buffer_load_dwordx4 v[60:63], v4, s[56:59], s11 offen offset:3072 sc1
L_W1E7:
    s_sub_u32 s9, s9, 32
    s_cbranch_scc1 L_END
    s_waitcnt vmcnt(0)
    s_bitcmp1_b32 s12, 0
    s_cbranch_scc0 L_W1H0
    v_xor_b32 v32, v12, v32
    v_xor_b32 v33, v13, v33
    v_xor_b32 v34, v14, v34
    v_xor_b32 v35, v15, v35
    v_or3_b32 v5, v32, v33, v34
    v_or_b32 v5, v5, v35
    v_and_b32 v5, 15, v5
    v_cmp_ne_u32 vcc, 0, v5
    s_cbranch_vccnz L_W1H0
    s_bitset0_b32 s12, 0
L_W1H0:
    s_bitcmp1_b32 s12, 1
    s_cbranch_scc0 L_W1H1
    v_xor_b32 v36, v12, v36
    v_xor_b32 v37, v13, v37
    v_xor_b32 v38, v14, v38
    v_xor_b32 v39, v15, v39
    v_or3_b32 v5, v36, v37, v38
    v_or_b32 v5, v5, v39
    v_and_b32 v5, 15, v5
    v_cmp_ne_u32 vcc, 0, v5
    s_cbranch_vccnz L_W1H1
    s_bitset0_b32 s12, 1
L_W1H1:
    s_bitcmp1_b32 s12, 2
    s_cbranch_scc0 L_W1H2
    v_xor_b32 v40, v12, v40
    v_xor_b32 v41, v13, v41
    v_xor_b32 v42, v14, v42
    v_xor_b32 v43, v15, v43
    v_or3_b32 v5, v40, v41, v42
    v_or_b32 v5, v5, v43
    v_and_b32 v5, 15, v5
    v_cmp_ne_u32 vcc, 0, v5
    s_cbranch_vccnz L_W1H2
    s_bitset0_b32 s12, 2
L_W1H2:
    s_bitcmp1_b32 s12, 3
    s_cbranch_scc0 L_W1H3
    v_xor_b32 v44, v12, v44
    v_xor_b32 v45, v13, v45
    v_xor_b32 v46, v14, v46
    v_xor_b32 v47, v15, v47
    v_or3_b32 v5, v44, v45, v46
    v_or_b32 v5, v5, v47
    v_and_b32 v5, 15, v5
    v_cmp_ne_u32 vcc, 0, v5
    s_cbranch_vccnz L_W1H3
    s_bitset0_b32 s12, 3
L_W1H3:
    s_bitcmp1_b32 s12, 4
    s_cbranch_scc0 L_W1H4
    v_xor_b32 v48, v12, v48
    v_xor_b32 v49, v13, v49
    v_xor_b32 v50, v14, v50
    v_xor_b32 v51, v15, v51
    v_or3_b32 v5, v48, v49, v50
    v_or_b32 v5, v5, v51
    v_and_b32 v5, 15, v5
    v_cmp_ne_u32 vcc, 0, v5
    s_cbranch_vccnz L_W1H4
    s_bitset0_b32 s12, 4
L_W1H4:
    s_bitcmp1_b32 s12, 5
    s_cbranch_scc0 L_W1H5
    v_xor_b32 v52, v12, v52
    v_xor_b32 v53, v13, v53
    v_xor_b32 v54, v14, v54
    v_xor_b32 v55, v15, v55
    v_or3_b32 v5, v52, v53, v54
    v_or_b32 v5, v5, v55
    v_and_b32 v5, 15, v5
    v_cmp_ne_u32 vcc, 0, v5
    s_cbranch_vccnz L_W1H5
    s_bitset0_b32 s12, 5
L_W1H5:
    s_bitcmp1_b32 s12, 6
    s_cbranch_scc0 L_W1H6
    v_xor_b32 v56, v12, v56
    v_xor_b32 v57, v13, v57
    v_xor_b32 v58, v14, v58
    v_xor_b32 v59, v15, v59
    v_or3_b32 v5, v56, v57, v58
    v_or_b32 v5, v5, v59
    v_and_b32 v5, 15, v5
    v_cmp_ne_u32 vcc, 0, v5
    s_cbranch_vccnz L_W1H6
    s_bitset0_b32 s12, 6
L_W1H6:
    s_bitcmp1_b32 s12, 7
    s_cbranch_scc0 L_W1H7
    v_xor_b32 v60, v12, v60
    v_xor_b32 v61, v13, v61
    v_xor_b32 v62, v14, v62
    v_xor_b32 v63, v15, v63
    v_or3_b32 v5, v60, v61, v62
    v_or_b32 v5, v5, v63
    v_and_b32 v5, 15, v5
    v_cmp_ne_u32 vcc, 0, v5
    s_cbranch_vccnz L_W1H7
    s_bitset0_b32 s12, 7
L_W1H7:
    s_cmp_lg_u32 s12, 0
    s_cbranch_scc1 L_W1E
    v_pk_add_f32 v[32:33], v[32:33], v[36:37]
    v_pk_add_f32 v[34:35], v[34:35], v[38:39]
    v_pk_add_f32 v[40:41], v[40:41], v[44:45]
    v_pk_add_f32 v[42:43], v[42:43], v[46:47]
    v_pk_add_f32 v[48:49], v[48:49], v[52:53]
    v_pk_add_f32 v[50:51], v[50:51], v[54:55]
    v_pk_add_f32 v[56:57], v[56:57], v[60:61]
    v_pk_add_f32 v[58:59], v[58:59], v[62:63]
    v_pk_add_f32 v[32:33], v[32:33], v[40:41]
    v_pk_add_f32 v[34:35], v[34:35], v[42:43]
    v_pk_add_f32 v[48:49], v[48:49], v[56:57]
    v_pk_add_f32 v[50:51], v[50:51], v[58:59]
    v_pk_add_f32 v[32:33], v[32:33], v[48:49]
    v_pk_add_f32 v[34:35], v[34:35], v[50:51]
    s_nop 1
    v_permlane16_swap_b32 v32, v34
    v_permlane16_swap_b32 v33, v35
    v_cvt_pk_bf16_f32 v32, v32, v32
    v_lshlrev_b32 v32, 16, v32
    v_mul_f32 v36, 0xbfb8aa3b, v32
    v_exp_f32 v36, v36
    s_nop 0
    v_add_f32 v36, 1.0, v36
    v_rcp_f32 v36, v36
    s_nop 0
    v_mul_f32 v32, v32, v36
    v_cvt_pk_bf16_f32 v32, v32, v32
    v_lshlrev_b32 v32, 16, v32
    v_cvt_pk_bf16_f32 v33, v33, v33
    v_lshlrev_b32 v33, 16, v33
    v_mul_f32 v37, 0xbfb8aa3b, v33
    v_exp_f32 v37, v37
    s_nop 0
    v_add_f32 v37, 1.0, v37
    v_rcp_f32 v37, v37
    s_nop 0
    v_mul_f32 v33, v33, v37
    v_cvt_pk_bf16_f32 v33, v33, v33
    v_lshlrev_b32 v33, 16, v33
    v_cvt_pk_bf16_f32 v34, v34, v34
    v_lshlrev_b32 v34, 16, v34
    v_cvt_pk_bf16_f32 v35, v35, v35
    v_lshlrev_b32 v35, 16, v35
    v_pk_mul_f32 v[32:33], v[32:33], v[34:35]
    v_and_b32 v9, 15, v1
    v_lshlrev_b32 v10, 2, v9
    s_lshl_b32 s10, s97, 6
    v_add_u32 v10, s10, v10
    v_cvt_pk_bf16_f32 v32, v32, v33
    v_cmp_gt_u32 vcc, 1376, v10
    v_lshlrev_b32 v9, 3, v9
    v_bfe_u32 v8, v1, 4, 1
    v_lshl_add_u32 v9, v8, 2, v9
    v_cndmask_b32 v32, 0, v32, vcc
    v_lshrrev_b32 v8, 5, v1
    v_lshl_add_u32 v9, v8, 7, v9
    ds_write_b32 v9, v32 offset:512
    v_lshrrev_b32 v9, 4, v1
    v_lshlrev_b32 v9, 5, v9
    v_and_b32 v10, 8, v1
    v_lshl_add_u32 v9, v10, 4, v9
    ds_read_b128 v[16:19], v9 offset:512
    ds_read_b128 v[20:23], v9 offset:528
    s_waitcnt lgkmcnt(0)
    s_branch L_B16
L_S2X:
    s_mov_b32 s68, s34
    s_mov_b32 s69, s35
    s_mov_b32 s70, 2048
    s_mov_b32 s71, 0x20000
    s_and_b32 s99, s2, 0xc0
    s_and_b32 s10, s2, 7
    s_lshl_b32 s10, s10, 3
    s_or_b32 s99, s99, s10
    s_bfe_u32 s10, s2, 0x30003
    s_or_b32 s99, s99, s10
    s_bfe_u32 s10, s99, 0x20005
    s_and_b32 s11, s99, 31
    s_lshl_b32 s11, s11, 4
    s_lshr_b32 s12, s99, 7
    s_lshl_b32 s12, s12, 9
    s_add_u32 s11, s11, s12
    s_mul_i32 s12, s10, 22528
    s_add_u32 s12, s12, s11
    s_add_u32 s98, s12, 1048576
    s_lshl_b32 s96, s10, 10
    s_add_u32 s96, s96, s11
    s_add_u32 s96, s96, 589824
    s_mul_i32 s97, s10, 4096
    s_bfe_u32 s12, s11, 0x30005
    s_lshl_b32 s12, s12, 3
    s_add_u32 s97, s97, s12
    s_bfe_u32 s12, s11, 0x10008
    s_mul_i32 s12, s12, 128
    s_add_u32 s97, s97, s12
    s_bfe_u32 s12, s11, 0x10004
    s_mul_i32 s12, s12, 256
    s_add_u32 s97, s97, s12
    s_bfe_u32 s12, s11, 0x10009
    s_mul_i32 s12, s12, 512
    s_add_u32 s97, s97, s12
    s_add_u32 s97, s97, 524288
    s_lshl_b32 s99, s6, 8
    v_and_b32 v64, 0x1ff, v3
    v_lshrrev_b32 v64, 1, v64
    v_lshrrev_b32 v65, 9, v3
    v_lshl_add_u32 v64, v65, 10, v64
    v_lshlrev_b32 v65, 10, v1
    v_mov_b32 v68, 0
    v_mov_b32 v69, 0
    v_mov_b32 v70, 0
    v_mov_b32 v71, 0
    v_mov_b32 v74, 0
    v_mov_b32 v75, 0
    v_lshrrev_b32 v72, 4, v1
    v_lshlrev_b32 v72, 10, v72
    buffer_load_dwordx2 v[76:77], v64, s[40:43], s99 offen
    s_mov_b32 s12, 0x00010001
    s_mov_b32 s13, 0x00010001
    s_mov_b64 exec, s[12:13]
    buffer_atomic_swap_x2 v[74:75], v72, s[56:59], s97 offen sc0 sc1
    buffer_atomic_swap_x2 v[70:71], v72, s[56:59], s97 offen offset:64 sc0 sc1
    s_mov_b64 exec, -1
    s_lshl_b32 s97, s6, 10
    s_add_u32 s97, s97, 589824
    v_mov_b32 v84, 0
    v_mov_b32 v85, 0
    v_mov_b32 v86, 0
    v_mov_b32 v87, 0
    s_waitcnt vmcnt(0)
L_W1Q:
    ds_read_b32 v5, v68 offset:28
    s_sub_u32 s9, s9, 1
    s_cbranch_scc1 L_END
    s_waitcnt lgkmcnt(0)
    v_readfirstlane_b32 s10, v5
    s_cmp_eq_u32 s10, 0
    s_cbranch_scc1 L_W1Q
    s_mov_b64 exec, 0x3fffff
L_W1G:
    buffer_load_dwordx4 v[84:87], v65, s[56:59], s98 offen sc1
    s_sub_u32 s9, s9, 32
    s_cbranch_scc1 L_END
    s_waitcnt vmcnt(0)
    v_xor_b32 v84, s64, v84
    v_xor_b32 v85, s65, v85
    v_xor_b32 v86, s66, v86
    v_xor_b32 v87, s67, v87
    v_or3_b32 v92, v84, v85, v86
    v_or_b32 v92, v92, v87
    v_and_b32 v92, 0x1ff, v92
    v_cmp_ne_u32 vcc, 0, v92
    s_mov_b64 exec, vcc
    s_cbranch_vccnz L_W1G
    s_mov_b64 exec, -1
    v_permlane32_swap_b32 v84, v86
    v_permlane32_swap_b32 v85, v87
    v_pk_add_f32 v[84:85], v[84:85], v[86:87]
    s_nop 1
    v_permlane16_swap_b32 v84, v85
    v_add_f32 v84, v84, v85
    s_nop 1
    v_add_f32_dpp v84, v84, v84 row_ror:8 row_mask:0xf bank_mask:0xf
    s_nop 1
    v_add_f32_dpp v84, v84, v84 row_ror:4 row_mask:0xf bank_mask:0xf
    s_nop 1
    v_add_f32_dpp v84, v84, v84 row_ror:2 row_mask:0xf bank_mask:0xf
    s_nop 1
    v_add_f32_dpp v84, v84, v84 row_ror:1 row_mask:0xf bank_mask:0xf
    v_cvt_pk_bf16_f32 v84, v84, v84
    v_lshlrev_b32 v84, 16, v84
    v_mul_f32 v85, 0xbfb8aa3b, v84
    v_exp_f32 v85, v85
    s_nop 0
    v_add_f32 v85, 1.0, v85
    v_rcp_f32 v85, v85
    s_nop 0
    v_mul_f32 v84, v84, v85
    v_cvt_pk_bf16_f32 v84, v84, v84
    v_lshlrev_b32 v84, 16, v84
    s_nop 0
    v_readlane_b32 s10, v84, 0
    v_readlane_b32 s11, v84, 16
    v_readlane_b32 s12, v84, 32
    v_readlane_b32 s13, v84, 48
    s_or_b32 s10, s10, s72
    v_mov_b32 v92, s10
    s_or_b32 s11, s11, s73
    v_mov_b32 v93, s11
    s_or_b32 s12, s12, s74
    v_mov_b32 v94, s12
    s_or_b32 s13, s13, s75
    v_mov_b32 v95, s13
    s_mov_b64 exec, 1
    buffer_store_dwordx4 v[92:95], off, s[56:59], s96 sc1
    s_mov_b64 exec, -1
L_W1F:
    ds_read_b32 v5, v68 offset:8
    s_sub_u32 s9, s9, 1
    s_cbranch_scc1 L_END
    s_waitcnt lgkmcnt(0)
    v_readfirstlane_b32 s10, v5
    s_cmp_lt_u32 s10, 8
    s_cbranch_scc1 L_W1F
L_TAIL:
    v_mov_b32 v8, 0
    v_and_b32 v9, 3, v1
    v_bfe_u32 v10, v1, 3, 1
    v_lshl_add_u32 v9, v10, 2, v9
    v_lshlrev_b32 v9, 10, v9
    v_lshrrev_b32 v10, 4, v1
    v_lshl_add_u32 v80, v10, 5, v9
    v_and_b32 v10, 4, v1
    v_lshl_add_u32 v80, v10, 2, v80
    v_mov_b32 v67, 262144
    s_lshl_b32 s14, s4, 13
    s_add_u32 s14, s14, 1572864
L_TB:
    ds_read_b32 v82, v8 offset:12
    s_sub_u32 s9, s9, 1
    s_cbranch_scc1 L_END
    s_waitcnt lgkmcnt(0)
    v_readfirstlane_b32 s11, v82
    s_cmp_lt_u32 s11, 2
    s_cbranch_scc1 L_TB
    s_mov_b32 s44, s24
    s_mov_b32 s45, s25
    s_mov_b32 s46, 0x400000
    s_mov_b32 s47, 0x20000
    v_lshrrev_b32 v83, 4, v1
    v_lshl_add_u32 v83, v83, 13, v2
    s_lshl_b32 s10, s4, 17
    s_lshl_b32 s11, s5, 16
    s_add_u32 s10, s10, s11
    s_lshl_b32 s11, s3, 15
    s_add_u32 s10, s10, s11
    s_lshl_b32 s11, s6, 8
    s_add_u32 s10, s10, s11
    s_add_u32 s11, s10, 0x1000
    buffer_load_dwordx4 v[32:35], v83, s[44:47], s10 offen offset:0 nt
    buffer_load_dwordx4 v[36:39], v83, s[44:47], s10 offen offset:1024 nt
    buffer_load_dwordx4 v[40:43], v83, s[44:47], s10 offen offset:2048 nt
    buffer_load_dwordx4 v[44:47], v83, s[44:47], s10 offen offset:3072 nt
    buffer_load_dwordx4 v[48:51], v83, s[44:47], s11 offen offset:0 nt
    buffer_load_dwordx4 v[52:55], v83, s[44:47], s11 offen offset:1024 nt
    buffer_load_dwordx4 v[56:59], v83, s[44:47], s11 offen offset:2048 nt
    buffer_load_dwordx4 v[60:63], v83, s[44:47], s11 offen offset:3072 nt
    s_lshl_b32 s10, s5, 8
    s_add_u32 s10, s10, s14
    s_lshl_b32 s11, s3, 7
    s_add_u32 s10, s10, s11
    s_mul_i32 s12, s6, 4096
    s_add_u32 s12, s12, 524288
    s_add_u32 s30, s12, 2048
    v_lshlrev_b32 v70, 4, v1
    s_lshl_b32 s11, s3, 10
    v_add_u32 v68, s11, v70
    v_xor_b32 v69, 1024, v68
    v_and_b32 v71, 7, v1
    v_lshlrev_b32 v71, 3, v71
    v_lshrrev_b32 v65, 3, v1
    v_lshl_add_u32 v71, v65, 7, v71
    v_mov_b32 v65, 1
    s_mov_b32 s26, 0
    s_mov_b32 s27, 0x40d80000
    s_mov_b32 s28, 0
    s_mov_b32 s29, 0x3d900000
    s_mov_b32 s13, 0x2000000
    s_mov_b32 s32, 0
    s_mov_b32 s33, 0x3f900000
    s_mov_b32 s31, 0x203ffff
    v_lshlrev_b32 v68, 3, v1
    v_add_u32 v68, s11, v68
    v_xor_b32 v69, 1024, v68
    s_lshl_b32 s11, s3, 3
    v_add_u32 v79, s11, v70
    s_lshl_b32 s11, s3, 2
    s_add_u32 s99, s99, s11
    s_cmp_eq_u32 s3, 0
    s_cbranch_scc1 L_SPM
    s_mov_b32 s12, s30
    v_mov_b32_dpp v24, v24 quad_perm:[2,3,0,1] row_mask:0xf bank_mask:0xf
    v_mov_b32_dpp v25, v25 quad_perm:[2,3,0,1] row_mask:0xf bank_mask:0xf
    v_mov_b32_dpp v26, v26 quad_perm:[2,3,0,1] row_mask:0xf bank_mask:0xf
    v_mov_b32_dpp v27, v27 quad_perm:[2,3,0,1] row_mask:0xf bank_mask:0xf
    v_mov_b32_dpp v28, v28 quad_perm:[2,3,0,1] row_mask:0xf bank_mask:0xf
    v_mov_b32_dpp v29, v29 quad_perm:[2,3,0,1] row_mask:0xf bank_mask:0xf
    v_mov_b32_dpp v30, v30 quad_perm:[2,3,0,1] row_mask:0xf bank_mask:0xf
    v_mov_b32_dpp v31, v31 quad_perm:[2,3,0,1] row_mask:0xf bank_mask:0xf
L_SPM:
    v_mov_b32 v4, 0
    v_mov_b32 v5, 0
    v_mov_b32 v6, 0
    v_mov_b32 v7, 0
L_TC:
    ds_read_b32 v82, v8 offset:12
    s_sub_u32 s9, s9, 1
    s_cbranch_scc1 L_END
    s_waitcnt lgkmcnt(0)
    v_readfirstlane_b32 s11, v82
    s_cmp_lt_u32 s11, 9
    s_cbranch_scc1 L_TC
    s_cmp_eq_u32 s3, 0
    s_cbranch_scc1 L_TH
    buffer_load_dwordx4 v[88:91], v3, s[56:59], s97 offen sc1
L_TH:
L_TM:
    v_or_b32 v11, v9, v67
    v_or_b32 v81, v80, v67
    buffer_load_dwordx4 v[20:23], v11, s[56:59], s14 offen offset:512 sc1
    buffer_load_dwordx4 v[12:15], v81, s[56:59], s10 offen sc1
    s_sub_u32 s9, s9, 32
    s_cbranch_scc1 L_END
    s_and_b32 s11, s9, 0x7fe0
    s_cselect_b32 s11, 0x7fffffff, -1
    s_waitcnt vmcnt(1)
    v_xor_b32 v22, s76, v22
    v_xor_b32 v23, s76, v23
    v_or_b32 v22, v22, v23
    v_xor_b32 v23, s79, v22
    v_min_u32 v22, v22, v23
    v_and_b32 v23, s11, v23
    v_cmp_eq_u32 vcc, 0, v23
    s_nop 1
    v_cndmask_b32 v67, 0, v67, vcc
    v_cmp_ne_u32 vcc, 0, v22
    s_cbranch_vccnz L_TM
    v_max_f32_dpp v10, v20, v20 quad_perm:[1,0,3,2] row_mask:0xf bank_mask:0xf
    s_nop 1
    v_max_f32_dpp v10, v10, v10 quad_perm:[2,3,0,1] row_mask:0xf bank_mask:0xf
    v_sub_f32 v20, v20, v10
    v_mul_f32 v20, 0x3fb8aa3b, v20
    v_exp_f32 v20, v20
    s_nop 0
    v_mul_f32 v11, v20, v21
    s_nop 1
    v_add_f32_dpp v11, v11, v11 quad_perm:[1,0,3,2] row_mask:0xf bank_mask:0xf
    s_nop 1
    v_add_f32_dpp v11, v11, v11 quad_perm:[2,3,0,1] row_mask:0xf bank_mask:0xf
    v_rcp_f32 v11, v11
    s_nop 0
    v_mul_f32 v20, v20, v11
    s_branch L_TOW
L_TO:
    v_or_b32 v81, v80, v67
    buffer_load_dwordx4 v[12:15], v81, s[56:59], s10 offen sc1
    s_sub_u32 s9, s9, 32
    s_cbranch_scc1 L_END
    s_and_b32 s11, s9, 32736
    s_cbranch_scc1 L_TOW
    v_mov_b32 v67, 0
L_TOW:
    s_waitcnt vmcnt(0)
L_TOX:
    v_xor_b32 v12, s64, v12
    v_xor_b32 v13, s65, v13
    v_xor_b32 v14, s66, v14
    v_xor_b32 v15, s67, v15
    v_or3_b32 v10, v12, v13, v14
    v_or_b32 v10, v10, v15
    v_and_b32 v10, 0x1ff, v10
    v_cmp_ne_u32 vcc, 0, v10
    s_mov_b64 exec, vcc
    s_cbranch_vccnz L_TO
    s_mov_b64 exec, -1
    v_pk_mul_f32 v[12:13], v[12:13], v[20:21] op_sel_hi:[1,0]
    v_pk_mul_f32 v[14:15], v[14:15], v[20:21] op_sel_hi:[1,0]
    s_nop 0
    v_add_f32_dpp v12, v12, v12 quad_perm:[1,0,3,2] row_mask:0xf bank_mask:0xf
    v_add_f32_dpp v13, v13, v13 quad_perm:[1,0,3,2] row_mask:0xf bank_mask:0xf
    v_add_f32_dpp v14, v14, v14 quad_perm:[1,0,3,2] row_mask:0xf bank_mask:0xf
    v_add_f32_dpp v15, v15, v15 quad_perm:[1,0,3,2] row_mask:0xf bank_mask:0xf
    v_add_f32_dpp v12, v12, v12 quad_perm:[2,3,0,1] row_mask:0xf bank_mask:0xf
    v_add_f32_dpp v13, v13, v13 quad_perm:[2,3,0,1] row_mask:0xf bank_mask:0xf
    v_add_f32_dpp v14, v14, v14 quad_perm:[2,3,0,1] row_mask:0xf bank_mask:0xf
    v_add_f32_dpp v15, v15, v15 quad_perm:[2,3,0,1] row_mask:0xf bank_mask:0xf
    v_cvt_pk_bf16_f32 v16, v12, v13
    v_cvt_pk_bf16_f32 v17, v14, v15
    v_cvt_pk_bf16_f32 v18, v12, v13
    v_cvt_pk_bf16_f32 v19, v14, v15
    s_nop 0
    v_mov_b32_dpp v18, v16 row_half_mirror row_mask:0xf bank_mask:0x5
    v_mov_b32_dpp v19, v17 row_half_mirror row_mask:0xf bank_mask:0x5
    v_mov_b32_dpp v16, v16 row_half_mirror row_mask:0xf bank_mask:0xa
    v_mov_b32_dpp v17, v17 row_half_mirror row_mask:0xf bank_mask:0xa
    v_perm_b32 v160, v16, v16, v24
    v_perm_b32 v161, v16, v16, v25
    v_perm_b32 v162, v16, v16, v26
    v_perm_b32 v163, v16, v16, v27
    s_nop 1
    v_mfma_f32_16x16x32_bf16 v[4:7], v[160:163], v[32:35], v[4:7]
    v_perm_b32 v164, v16, v16, v28
    v_perm_b32 v165, v16, v16, v29
    v_perm_b32 v166, v16, v16, v30
    v_perm_b32 v167, v16, v16, v31
    s_nop 1
    v_mfma_f32_16x16x32_bf16 v[4:7], v[164:167], v[36:39], v[4:7]
    v_perm_b32 v160, v17, v17, v24
    v_perm_b32 v161, v17, v17, v25
    v_perm_b32 v162, v17, v17, v26
    v_perm_b32 v163, v17, v17, v27
    s_nop 1
    v_mfma_f32_16x16x32_bf16 v[4:7], v[160:163], v[40:43], v[4:7]
    s_cmp_eq_u32 s3, 0
    s_cbranch_scc1 L_AXG
    s_branch L_W1R
L_W1P:
    buffer_load_dwordx4 v[88:91], v3, s[56:59], s97 offen sc1
    s_sub_u32 s9, s9, 32
    s_cbranch_scc1 L_END
    s_waitcnt vmcnt(0)
L_W1R:
    v_xor_b32 v88, s64, v88
    v_xor_b32 v89, s65, v89
    v_xor_b32 v90, s66, v90
    v_xor_b32 v91, s67, v91
    v_or3_b32 v92, v88, v89, v90
    v_or_b32 v92, v92, v91
    v_and_b32 v92, 0x1ff, v92
    v_cmp_ne_u32 vcc, 0, v92
    s_mov_b64 exec, vcc
    s_cbranch_vccnz L_W1P
    s_mov_b64 exec, -1
    s_mov_b32 s10, 0x07060100
    s_mov_b32 s11, 0x07060302
    v_perm_b32 v88, v88, v76, s10
    v_perm_b32 v89, v89, v76, s11
    v_perm_b32 v90, v90, v77, s10
    v_perm_b32 v91, v91, v77, s11
    ds_write_b128 v70, v[88:91] offset:5120
L_AXG:
    v_perm_b32 v164, v17, v17, v28
    v_perm_b32 v165, v17, v17, v29
    v_perm_b32 v166, v17, v17, v30
    v_perm_b32 v167, v17, v17, v31
    s_nop 1
    v_mfma_f32_16x16x32_bf16 v[4:7], v[164:167], v[44:47], v[4:7]
    v_perm_b32 v160, v18, v18, v24
    v_perm_b32 v161, v18, v18, v25
    v_perm_b32 v162, v18, v18, v26
    v_perm_b32 v163, v18, v18, v27
    s_nop 1
    v_mfma_f32_16x16x32_bf16 v[4:7], v[160:163], v[48:51], v[4:7]
    v_perm_b32 v164, v18, v18, v28
    v_perm_b32 v165, v18, v18, v29
    v_perm_b32 v166, v18, v18, v30
    v_perm_b32 v167, v18, v18, v31
    s_nop 1
    v_mfma_f32_16x16x32_bf16 v[4:7], v[164:167], v[52:55], v[4:7]
    v_perm_b32 v160, v19, v19, v24
    v_perm_b32 v161, v19, v19, v25
    v_perm_b32 v162, v19, v19, v26
    v_perm_b32 v163, v19, v19, v27
    s_nop 1
    v_mfma_f32_16x16x32_bf16 v[4:7], v[160:163], v[56:59], v[4:7]
    v_perm_b32 v164, v19, v19, v28
    v_perm_b32 v165, v19, v19, v29
    v_perm_b32 v166, v19, v19, v30
    v_perm_b32 v167, v19, v19, v31
    s_nop 1
    v_mfma_f32_16x16x32_bf16 v[4:7], v[164:167], v[60:63], v[4:7]
    s_nop 7
    ds_write_b64 v68, v[6:7] offset:1024
    s_mov_b64 exec, 1
    ds_add_rtn_u32 v10, v8, v65 offset:24
    s_mov_b64 exec, -1
    ds_read_b64 v[12:13], v69 offset:1024
    ds_read_b64 v[16:17], v79 offset:5120
    s_waitcnt lgkmcnt(2)
    v_readfirstlane_b32 s11, v10
    s_cmp_eq_u32 s11, 0
    s_cbranch_scc1 L_AXS
L_AXT:
    s_waitcnt lgkmcnt(1)
    v_pk_add_f32 v[4:5], v[4:5], v[12:13]
    v_cvt_f64_f32 v[32:33], v4
    v_cvt_f64_f32 v[34:35], v5
    v_add_f64 v[20:21], v[32:33], s[26:27]
    v_add_f64 v[22:23], v[34:35], s[26:27]
    v_add_f64 v[32:33], v[20:21], -s[26:27]
    v_add_u32 v21, 0xc12a0000, v21
    v_add_f64 v[34:35], v[22:23], -s[26:27]
    v_add_u32 v23, 0xc12a0000, v23
    v_or3_b32 v10, v21, v23, s13
    v_cmp_lt_u32 vcc, s31, v10
    s_cbranch_vccnz L_AXO
L_AXA:
    buffer_atomic_add_x2 v[20:21], v71, s[56:59], s12 offen offset:0 sc0 sc1
    buffer_atomic_add_x2 v[22:23], v71, s[56:59], s12 offen offset:1024 sc0 sc1
    s_waitcnt lgkmcnt(0)
    v_and_b32 v40, 0xffff0000, v16
    v_lshlrev_b32 v44, 16, v16
    v_and_b32 v41, 0xffff0000, v17
    v_lshlrev_b32 v45, 16, v17
    s_waitcnt vmcnt(1)
    v_cvt_f64_u32 v[48:49], v20
    v_add_u32 v20, 0x81820000, v21
    v_cvt_f64_i32 v[50:51], v20
    v_fma_f64 v[32:33], v[48:49], s[28:29], v[32:33]
    v_bfe_u32 v12, v21, 25, 6
    v_fma_f64 v[48:49], v[50:51], s[32:33], v[32:33]
    v_cmp_eq_u32 s[96:97], 63, v12
    v_cvt_f32_f64 v4, v[48:49]
    s_waitcnt vmcnt(0)
    v_cvt_f64_u32 v[52:53], v22
    v_add_u32 v22, 0x81820000, v23
    v_cvt_f64_i32 v[54:55], v22
    v_fma_f64 v[34:35], v[52:53], s[28:29], v[34:35]
    v_bfe_u32 v13, v23, 25, 6
    v_fma_f64 v[52:53], v[54:55], s[32:33], v[34:35]
    v_cmp_eq_u32 s[100:101], 63, v13
    v_cvt_f32_f64 v5, v[52:53]
    v_or_b32 v10, v21, v23
    v_cmp_gt_i32 vcc, 0, v10
    s_cbranch_vccnz L_AXR
L_AXB:
    v_cvt_pk_bf16_f32 v12, v4, v5
    s_and_b64 s[16:17], s[96:97], s[100:101]
    v_lshlrev_b32 v4, 16, v12
    v_and_b32 v5, 0xffff0000, v12
    v_pk_mul_f32 v[4:5], v[4:5], v[40:41]
    s_xor_b64 s[20:21], s[96:97], s[100:101]
    v_cvt_pk_bf16_f32 v12, v4, v5
    v_lshlrev_b32 v4, 16, v12
    v_and_b32 v5, 0xffff0000, v12
    v_pk_add_f32 v[4:5], v[4:5], v[44:45]
    v_cvt_pk_bf16_f32 v12, v4, v5
    s_mov_b64 exec, s[16:17]
    s_cbranch_execz L_AX1
    buffer_store_dword v12, v64, s[68:71], s99 offen
L_AX1:
    s_and_b64 exec, s[96:97], s[20:21]
    s_cbranch_execz L_AX2
    buffer_store_short v12, v64, s[68:71], s99 offen offset:0
L_AX2:
    s_and_b64 exec, s[100:101], s[20:21]
    s_cbranch_execz L_AX3
    buffer_store_short_d16_hi v12, v64, s[68:71], s99 offen offset:2
L_AX3:
    s_endpgm
L_AXS:
    ds_read_b32 v10, v8 offset:24
    ds_read_b64 v[12:13], v69 offset:1024
    ds_read_b64 v[16:17], v79 offset:5120
    s_sub_u32 s9, s9, 1
    s_cbranch_scc1 L_END
    s_waitcnt lgkmcnt(2)
    v_readfirstlane_b32 s11, v10
    s_cmp_lt_u32 s11, 2
    s_cbranch_scc1 L_AXS
    s_branch L_AXT
L_AXO:
    v_subrev_u32 v10, s13, v21
    v_cmp_lt_u32 vcc, 0x3ffff, v10
    s_mov_b64 exec, vcc
    s_cbranch_execz L_AXO0
    v_cvt_f64_f32 v[12:13], v4
    buffer_atomic_add_f64 v[12:13], v71, s[56:59], s12 offen offset:64 sc0 sc1
    s_waitcnt vmcnt(0)
    v_mov_b32 v12, 0
    v_mov_b32 v13, 0x80000000
    buffer_atomic_or_x2 v[12:13], v71, s[56:59], s12 offen offset:0 sc0 sc1
    s_waitcnt vmcnt(0)
    v_mov_b32 v20, 0
    v_mov_b32 v21, 0x2020000
    v_mov_b32 v32, 0
    v_mov_b32 v33, 0
L_AXO0:
    s_mov_b64 exec, -1
    v_subrev_u32 v10, s13, v23
    v_cmp_lt_u32 vcc, 0x3ffff, v10
    s_mov_b64 exec, vcc
    s_cbranch_execz L_AXO1
    v_cvt_f64_f32 v[12:13], v5
    buffer_atomic_add_f64 v[12:13], v71, s[56:59], s12 offen offset:1088 sc0 sc1
    s_waitcnt vmcnt(0)
    v_mov_b32 v12, 0
    v_mov_b32 v13, 0x80000000
    buffer_atomic_or_x2 v[12:13], v71, s[56:59], s12 offen offset:1024 sc0 sc1
    s_waitcnt vmcnt(0)
    v_mov_b32 v22, 0
    v_mov_b32 v23, 0x2020000
    v_mov_b32 v34, 0
    v_mov_b32 v35, 0
L_AXO1:
    s_mov_b64 exec, -1
    s_branch L_AXA
L_AXR:
    buffer_load_dwordx2 v[48:49], v71, s[56:59], s12 offen offset:64 sc0 sc1
    buffer_load_dwordx2 v[52:53], v71, s[56:59], s12 offen offset:1088 sc0 sc1
    s_waitcnt vmcnt(0)
    v_bfe_i32 v20, v20, 0, 25
    v_cvt_f64_i32 v[50:51], v20
    v_fma_f64 v[32:33], v[50:51], s[32:33], v[32:33]
    v_add_f64 v[48:49], v[48:49], v[32:33]
    v_cvt_f32_f64 v4, v[48:49]
    v_bfe_i32 v22, v22, 0, 25
    v_cvt_f64_i32 v[54:55], v22
    v_fma_f64 v[34:35], v[54:55], s[32:33], v[34:35]
    v_add_f64 v[52:53], v[52:53], v[34:35]
    v_cvt_f32_f64 v5, v[52:53]
    s_branch L_AXB
L_END:
    s_endpgm
.section .rodata,"a"
.p2align 6
.amdhsa_kernel recurrent_scan__sliding_block_cached__swiglu_ffn__decode_kernel
  .amdhsa_next_free_vgpr 168
  .amdhsa_next_free_sgpr 102
  .amdhsa_accum_offset 168
  .amdhsa_group_segment_fixed_size 0
  .amdhsa_kernarg_size 96
  .amdhsa_user_sgpr_count 2
  .amdhsa_user_sgpr_kernarg_segment_ptr 1
  .amdhsa_system_sgpr_workgroup_id_x 1
.end_amdhsa_kernel
```
